```python
import torch

def _softmax(x, axis=-1):
    return torch.softmax(x, dim=axis)
def _gelu(x):
    return torch.nn.functional.gelu(x, approximate="tanh")
def _silu(x):
    return torch.nn.functional.silu(x)
def _sigmoid(x):
    return torch.sigmoid(x)
def _layernorm(x, axis=-1, eps=1e-5):
    m = x.mean(dim=axis, keepdim=True)
    v = x.var(dim=axis, keepdim=True, unbiased=False)
    return (x - m) / torch.sqrt(v + eps)
def _scatter_add(tgt, idx, src, axis=0):
    return tgt.clone().index_add_(axis, idx, src)
def _segment_sum(src, seg, n):
    out = torch.zeros((n,) + src.shape[1:], dtype=src.dtype)
    return out.index_add_(0, seg, src)
def _pad(x, pw):
    flat = tuple(v for pair in reversed(pw) for v in pair)
    return torch.nn.functional.pad(x, flat)

kernel_name = 'sequential_preLN__sliding_block_cached__glu_gated_geglu__decode'

def setup_inputs():

    _w = (lambda a: (lambda t: t.to(torch.bfloat16) if t.is_floating_point() else t)(torch.as_tensor(a)))
    def _A_setup():
        B, Sq, D = 1, 1, 448
        Hq, Hkv, Sk, Dh = 16, 8, 16384, 256
        assert Hq % Hkv == 0, (Hq, Hkv)
        return {
            "x": _w((lambda *s: torch.randn(*s, dtype=torch.bfloat16) * 0.05)(B, Sq, D)),
            "k_cache": _w((lambda *s: torch.randn(*s, dtype=torch.bfloat16) * 1.6)(B, Hkv, Sk, Dh)),
            "v_cache": _w((lambda *s: torch.randn(*s, dtype=torch.bfloat16) * 0.8)(B, Hkv, Sk, Dh)),
            "wq": _w((lambda *s: torch.randn(*s, dtype=torch.bfloat16) * 1.6)(D, Hq * Dh) * (D ** -0.5)),
            "wo": _w((lambda *s: torch.randn(*s, dtype=torch.bfloat16) * 0.8)(Hq * Dh, D) * ((Hq * Dh) ** -0.5)),
        }
    _A_in = _A_setup()

    def _B_setup():
        B, S, Dm, Df = 1, 1, 448, 1792
        return {
            "x": _w((lambda *s: torch.randn(*s, dtype=torch.bfloat16) * 0.05)(B, S, Dm)),
            "w_gate": _w((lambda *s: torch.randn(*s, dtype=torch.bfloat16) * 0.8)(Dm, Df) * (Dm ** -0.5)),
            "w_up": _w((lambda *s: torch.randn(*s, dtype=torch.bfloat16) * 0.8)(Dm, Df) * (Dm ** -0.5)),
            "w_down": _w((lambda *s: torch.randn(*s, dtype=torch.bfloat16) * 0.8)(Df, Dm) * (Df ** -0.5)),
        }
    _B_in = _B_setup()

    return {
        "A_x": _A_in["x"],
        "A_k_cache": _A_in["k_cache"],
        "A_v_cache": _A_in["v_cache"],
        "A_wq": _A_in["wq"],
        "A_wo": _A_in["wo"],
        "B_x": _B_in["x"],
        "B_w_gate": _B_in["w_gate"],
        "B_w_up": _B_in["w_up"],
        "B_w_down": _B_in["w_down"],
    }

def reference(A_x, A_k_cache, A_v_cache, A_wq, A_wo, B_x, B_w_gate, B_w_up, B_w_down):
    def _A_ref(x, k_cache, v_cache, wq, wo):
        B, Sq, D = x.shape
        Hq, Dh = 16, 256
        Hkv, Sk = k_cache.shape[1], k_cache.shape[2]
        W = min(4096, max(256, Sk // 4))
        rep = Hq // Hkv
        q = (lambda x, *d: x.permute(*d))((x @ wq).reshape(B, Sq, Hq, Dh), 0, 2, 1, 3)
        k = (lambda x, n, axis: torch.repeat_interleave(x, n, dim=axis))(k_cache[:, :, Sk - W:, :], rep, axis=1)
        v = (lambda x, n, axis: torch.repeat_interleave(x, n, dim=axis))(v_cache[:, :, Sk - W:, :], rep, axis=1)
        scores = torch.einsum("bhqd,bhkd->bhqk", q, k) * (Dh ** -0.5)
        p = _softmax(scores, axis=-1)
        o = torch.einsum("bhqk,bhkd->bhqd", p, v)
        return (lambda x, *d: x.permute(*d))(o, 0, 2, 1, 3).reshape(B, Sq, Hq * Dh) @ wo

    def _B_ref(x, w_gate, w_up, w_down):
        g = torch.einsum("bsd,df->bsf", x, w_gate)
        u = torch.einsum("bsd,df->bsf", x, w_up)
        h = _gelu(g) * u
        return torch.einsum("bsf,fd->bsd", h, w_down)

    x = A_x
    h = x + _A_ref(_layernorm(x, axis=-1), A_k_cache, A_v_cache, A_wq, A_wo)
    h2 = h + _B_ref(_layernorm(h, axis=-1), B_w_gate, B_w_up, B_w_down)
    return h2
```

```asm
; @launch grid=(256,1,1) block=(640,1,1) lds=148864
.amdgcn_target "amdgcn-amd-amdhsa--gfx950"
.text
.globl sequential_preLN__sliding_block_cached__glu_gated_geglu__decode_kernel
.p2align 8
.type sequential_preLN__sliding_block_cached__glu_gated_geglu__decode_kernel,@function
sequential_preLN__sliding_block_cached__glu_gated_geglu__decode_kernel:
KSTART:
    s_load_dwordx16 s[4:19], s[0:1], 0
    s_load_dwordx8 s[20:27], s[0:1], 64
    s_cmp_ge_u32 s2, 256
    s_cbranch_scc1 L_end
    v_lshrrev_b32 v1, 6, v0
    v_and_b32 v0, 63, v0
    s_and_b32 s28, s2, 7
    v_readfirstlane_b32 s30, v1
    s_lshr_b32 s29, s2, 3
    s_mov_b32 s38, 0x100000
    s_sub_u32 s30, s30, 1
    s_cbranch_scc0 L_compute
    s_setprio 3
    v_lshrrev_b32 v2, 3, v0
    v_and_b32 v3, 7, v0
    v_lshrrev_b32 v4, 4, v0
    s_and_b32 s65, s29, 3
    s_mul_i32 s65, s65, 917504
    v_lshlrev_b32 v4, 1, v4
    v_xor_b32 v3, v3, v4
    v_lshlrev_b32 v3, 4, v3
    s_lshr_b32 s66, s29, 2
    s_lshl_b32 s66, s66, 7
    s_lshl_b32 s67, s28, 10
    s_add_u32 s65, s65, s66
    s_add_u32 s65, s65, s67
    v_lshl_add_u32 v8, v2, 13, v3
    s_mov_b32 s50, 909440
    s_mov_b32 s51, 0x20000
    s_mov_b32 m0, 131072
    s_mov_b32 s68, 0
    s_waitcnt lgkmcnt(0)
    s_add_u32 s48, s10, s65
    s_addc_u32 s49, s11, 0
    s_add_u32 s26, s26, 0xf800000
    s_addc_u32 s27, s27, 0
L_wq_1:
    buffer_load_dwordx4 v8, s[48:51], s68 offen nt lds
    s_add_u32 m0, m0, 1024
    s_add_u32 s68, s68, 65536
    buffer_load_dwordx4 v8, s[48:51], s68 offen nt lds
    s_add_u32 m0, m0, 1024
    s_add_u32 s68, s68, 65536
    s_cmp_lt_u32 s68, 917504
    s_cbranch_scc1 L_wq_1
    v_lshrrev_b32 v5, 5, v0
    v_and_b32 v6, 31, v0
    s_lshl_b32 s64, s28, 23
    s_lshl_b32 s65, s29, 16
    s_add_u32 s64, s64, s65
    s_add_u32 s64, s64, 6291456
    v_xor_b32 v7, v6, v5
    v_lshlrev_b32 v7, 4, v7
    v_lshl_add_u32 v10, v5, 9, v7
    s_add_u32 s40, s6, s64
    s_addc_u32 s41, s7, 0
    s_mov_b32 s42, 65536
    s_mov_b32 s43, 0x20000
    v_xor_b32 v11, 32, v10
    v_xor_b32 v12, 64, v10
    v_xor_b32 v13, 96, v10
    v_xor_b32 v14, 128, v10
    v_xor_b32 v15, 160, v10
    v_xor_b32 v16, 192, v10
    v_xor_b32 v17, 224, v10
    s_mov_b32 m0, 0
    s_mov_b32 s68, 0
L_kpre_2:
    buffer_load_dwordx4 v10, s[40:43], s68 offen offset:0 nt lds
    buffer_load_dwordx4 v11, s[40:43], s68 offen offset:1024 nt lds
    buffer_load_dwordx4 v12, s[40:43], s68 offen offset:2048 nt lds
    buffer_load_dwordx4 v13, s[40:43], s68 offen offset:3072 nt lds
    s_add_u32 m0, m0, 4096
    s_add_u32 s68, s68, 4096
    buffer_load_dwordx4 v14, s[40:43], s68 offen offset:0 nt lds
    buffer_load_dwordx4 v15, s[40:43], s68 offen offset:1024 nt lds
    buffer_load_dwordx4 v16, s[40:43], s68 offen offset:2048 nt lds
    buffer_load_dwordx4 v17, s[40:43], s68 offen offset:3072 nt lds
    s_add_u32 m0, m0, 4096
    s_add_u32 s68, s68, 4096
    s_cmp_lt_u32 s68, 24576
    s_cbranch_scc1 L_kpre_2
    v_lshlrev_b32 v7, 1, v5
    v_xor_b32 v7, v6, v7
    v_lshlrev_b32 v7, 4, v7
    v_lshl_add_u32 v18, v5, 9, v7
    v_xor_b32 v19, 64, v18
    v_xor_b32 v20, 128, v18
    v_xor_b32 v21, 192, v18
    v_lshlrev_b32 v9, 4, v0
    v_mov_b32 v22, 148352
    s_add_u32 s44, s8, s64
    s_addc_u32 s45, s9, 0
    s_mov_b32 s46, 65536
    s_mov_b32 s47, 0x20000
    s_lshl_b32 s65, s28, 13
    s_lshl_b32 s66, s29, 8
    s_add_u32 s65, s65, s66
    s_add_u32 s65, s65, 131072
    v_and_b32 v26, 1, v0
    v_lshlrev_b32 v26, 7, v26
    v_add_u32 v26, s65, v26
    s_lshl_b32 s65, s28, 9
    s_and_b32 s66, s29, 3
    s_lshl_b32 s66, s66, 7
    s_add_u32 s65, s65, s66
    s_add_u32 s65, s65, 4096
    v_and_b32 v27, 1, v0
    v_lshlrev_b32 v27, 12, v27
    v_add_u32 v27, s65, v27
    v_cmp_lt_u32 vcc, 1, v0
    s_nop 1
    v_cndmask_b32 v26, v26, v27, vcc
    s_mov_b64 exec, 15
    global_load_dword v31, v26, s[26:27]
    s_mov_b64 exec, -1
    s_barrier
    s_mul_i32 s65, s28, 69632
    s_mul_i32 s66, s29, 2176
    s_add_u32 s65, s65, s66
    s_add_u32 s65, s65, 196608
    v_lshlrev_b32 v28, 7, v0
    v_add_u32 v28, s65, v28
    s_mul_i32 s65, s28, 28800
    s_lshl_b32 s66, s29, 10
    s_add_u32 s65, s65, s66
    s_add_u32 s65, s65, 2097152
    v_and_b32 v29, 7, v0
    v_lshlrev_b32 v29, 7, v29
    v_add_u32 v29, s65, v29
    v_cmp_lt_u32 vcc, 23, v0
    s_nop 1
    v_cndmask_b32 v28, v28, v29, vcc
    s_mov_b32 exec_lo, 0xffff
    s_mov_b32 exec_hi, 0
    global_load_dword v31, v28, s[26:27]
    s_mov_b64 exec, -1
    s_waitcnt vmcnt(26)
    v_mov_b32 v23, 14
    s_mov_b64 exec, 1
    ds_write_b32 v22, v23
    s_mov_b64 exec, -1
    s_mov_b32 s69, 22
L_kmain_3:
    buffer_load_dwordx4 v10, s[40:43], s68 offen offset:0 nt lds
    buffer_load_dwordx4 v11, s[40:43], s68 offen offset:1024 nt lds
    buffer_load_dwordx4 v12, s[40:43], s68 offen offset:2048 nt lds
    buffer_load_dwordx4 v13, s[40:43], s68 offen offset:3072 nt lds
    s_add_u32 m0, m0, 4096
    s_add_u32 s68, s68, 4096
    buffer_load_dwordx4 v14, s[40:43], s68 offen offset:0 nt lds
    buffer_load_dwordx4 v15, s[40:43], s68 offen offset:1024 nt lds
    buffer_load_dwordx4 v16, s[40:43], s68 offen offset:2048 nt lds
    buffer_load_dwordx4 v17, s[40:43], s68 offen offset:3072 nt lds
    s_add_u32 m0, m0, 4096
    s_add_u32 s68, s68, 4096
    s_waitcnt vmcnt(24)
    v_mov_b32 v23, s69
    s_mov_b64 exec, 1
    ds_write_b32 v22, v23
    s_mov_b64 exec, -1
    s_add_u32 s69, s69, 8
    s_cmp_lt_u32 s68, 65536
    s_cbranch_scc1 L_kmain_3
    s_lshl_b32 s65, s28, 9
    s_lshl_b32 s66, s29, 4
    s_add_u32 s65, s65, s66
    s_mul_i32 s65, s65, 896
    s_add_u32 s48, s12, s65
    s_addc_u32 s49, s13, 0
    s_mov_b32 s50, 14336
    s_mov_b32 s51, 0x20000
    s_mov_b32 m0, 65536
    s_mov_b32 s68, 0
    s_mov_b32 s67, 65536
L_vmain_4:
    buffer_load_dwordx4 v18, s[44:47], s68 offen offset:0 nt lds
    buffer_load_dwordx4 v19, s[44:47], s68 offen offset:1024 nt lds
    buffer_load_dwordx4 v20, s[44:47], s68 offen offset:2048 nt lds
    buffer_load_dwordx4 v21, s[44:47], s68 offen offset:3072 nt lds
    s_add_u32 m0, m0, 4096
    s_add_u32 s68, s68, 4096
    buffer_load_dwordx4 v18, s[44:47], s68 offen offset:0 nt lds
    buffer_load_dwordx4 v19, s[44:47], s68 offen offset:1024 nt lds
    buffer_load_dwordx4 v20, s[44:47], s68 offen offset:2048 nt lds
    buffer_load_dwordx4 v21, s[44:47], s68 offen offset:3072 nt lds
    s_add_u32 m0, m0, 4096
    s_add_u32 s68, s68, 4096
    s_waitcnt vmcnt(24)
    v_mov_b32 v23, s69
    s_mov_b64 exec, 1
    ds_write_b32 v22, v23
    s_mov_b64 exec, -1
    s_add_u32 s69, s69, 8
    s_cmp_lt_u32 s68, s67
    s_cbranch_scc1 L_vmain_4
    v_and_b32 v24, 3, v0
    v_lshlrev_b32 v24, 2, v24
    v_add_u32 v24, 148368, v24
    s_branch L_wf_5
L_wf_5_r:
    s_sub_u32 s38, s38, 1
    s_cbranch_scc1 L_abort
L_wf_5:
    ds_read_b32 v25, v24
    s_waitcnt lgkmcnt(0)
    v_cmp_ne_u32 vcc, 1, v25
    s_cbranch_vccnz L_wf_5_r
    s_mov_b32 m0, 131072
    s_mov_b32 s68, 0
    buffer_load_dwordx4 v9, s[48:51], s68 offen offset:0 nt lds
    buffer_load_dwordx4 v9, s[48:51], s68 offen offset:1024 nt lds
    buffer_load_dwordx4 v9, s[48:51], s68 offen offset:2048 nt lds
    buffer_load_dwordx4 v9, s[48:51], s68 offen offset:3072 nt lds
    s_mov_b32 m0, 135168
    s_mov_b32 s68, 4096
    buffer_load_dwordx4 v9, s[48:51], s68 offen offset:0 nt lds
    buffer_load_dwordx4 v9, s[48:51], s68 offen offset:1024 nt lds
    buffer_load_dwordx4 v9, s[48:51], s68 offen offset:2048 nt lds
    buffer_load_dwordx4 v9, s[48:51], s68 offen offset:3072 nt lds
    s_mov_b32 m0, 139264
    s_mov_b32 s68, 8192
    buffer_load_dwordx4 v9, s[48:51], s68 offen offset:0 nt lds
    buffer_load_dwordx4 v9, s[48:51], s68 offen offset:1024 nt lds
    buffer_load_dwordx4 v9, s[48:51], s68 offen offset:2048 nt lds
    buffer_load_dwordx4 v9, s[48:51], s68 offen offset:3072 nt lds
    s_mov_b32 m0, 143360
    s_mov_b32 s68, 12288
    buffer_load_dwordx4 v9, s[48:51], s68 offen offset:0 nt lds
    buffer_load_dwordx4 v9, s[48:51], s68 offen offset:1024 nt lds
    s_waitcnt vmcnt(30)
    v_mov_b32 v23, 126
    s_mov_b64 exec, 1
    ds_write_b32 v22, v23
    s_mov_b64 exec, -1
    s_waitcnt vmcnt(22)
    v_mov_b32 v23, 134
    s_mov_b64 exec, 1
    ds_write_b32 v22, v23
    s_mov_b64 exec, -1
    s_waitcnt vmcnt(14)
    v_mov_b32 v23, 142
    s_mov_b64 exec, 1
    ds_write_b32 v22, v23
    s_mov_b64 exec, -1
    s_waitcnt vmcnt(0)
    v_mov_b32 v23, 156
    s_mov_b64 exec, 1
    ds_write_b32 v22, v23
    s_mov_b64 exec, -1
    s_cmp_ge_u32 s29, 28
    s_cbranch_scc1 L_loader_end
    v_add_u32 v32, 0, v0
    v_mul_u32_u24 v33, 2341, v32
    v_lshrrev_b32 v33, 16, v33
    v_mul_u32_u24 v34, 28, v33
    v_sub_u32 v34, v32, v34
    v_lshlrev_b32 v34, 4, v34
    v_mul_u32_u24 v33, 3584, v33
    v_add_u32 v10, v33, v34
    v_add_u32 v32, 64, v0
    v_mul_u32_u24 v33, 2341, v32
    v_lshrrev_b32 v33, 16, v33
    v_mul_u32_u24 v34, 28, v33
    v_sub_u32 v34, v32, v34
    v_lshlrev_b32 v34, 4, v34
    v_mul_u32_u24 v33, 3584, v33
    v_add_u32 v11, v33, v34
    v_subrev_u32 v11, 1024, v11
    v_add_u32 v32, 128, v0
    v_mul_u32_u24 v33, 2341, v32
    v_lshrrev_b32 v33, 16, v33
    v_mul_u32_u24 v34, 28, v33
    v_sub_u32 v34, v32, v34
    v_lshlrev_b32 v34, 4, v34
    v_mul_u32_u24 v33, 3584, v33
    v_add_u32 v12, v33, v34
    v_subrev_u32 v12, 2048, v12
    v_add_u32 v32, 192, v0
    v_mul_u32_u24 v33, 2341, v32
    v_lshrrev_b32 v33, 16, v33
    v_mul_u32_u24 v34, 28, v33
    v_sub_u32 v34, v32, v34
    v_lshlrev_b32 v34, 4, v34
    v_mul_u32_u24 v33, 3584, v33
    v_add_u32 v13, v33, v34
    v_subrev_u32 v13, 3072, v13
    v_add_u32 v32, 256, v0
    v_mul_u32_u24 v33, 2341, v32
    v_lshrrev_b32 v33, 16, v33
    v_mul_u32_u24 v34, 28, v33
    v_sub_u32 v34, v32, v34
    v_lshlrev_b32 v34, 4, v34
    v_mul_u32_u24 v33, 3584, v33
    v_add_u32 v14, v33, v34
    v_add_u32 v32, 320, v0
    v_mul_u32_u24 v33, 2341, v32
    v_lshrrev_b32 v33, 16, v33
    v_mul_u32_u24 v34, 28, v33
    v_sub_u32 v34, v32, v34
    v_lshlrev_b32 v34, 4, v34
    v_mul_u32_u24 v33, 3584, v33
    v_add_u32 v15, v33, v34
    v_subrev_u32 v15, 1024, v15
    v_add_u32 v32, 384, v0
    v_mul_u32_u24 v33, 2341, v32
    v_lshrrev_b32 v33, 16, v33
    v_mul_u32_u24 v34, 28, v33
    v_sub_u32 v34, v32, v34
    v_lshlrev_b32 v34, 4, v34
    v_mul_u32_u24 v33, 3584, v33
    v_add_u32 v16, v33, v34
    v_subrev_u32 v16, 2048, v16
    s_mul_i32 s65, s29, 57344
    s_mul_i32 s66, s28, 448
    s_add_u32 s65, s65, s66
    s_add_u32 s52, s16, s65
    s_addc_u32 s53, s17, 0
    s_mov_b32 s54, 54208
    s_mov_b32 s55, 0x20000
    s_add_u32 s56, s18, s65
    s_addc_u32 s57, s19, 0
    s_mov_b32 s58, 54208
    s_mov_b32 s59, 0x20000
    s_mul_i32 s65, s28, 224
    s_lshl_b32 s66, s29, 3
    s_add_u32 s65, s65, s66
    s_mul_i32 s65, s65, 896
    s_add_u32 s60, s20, s65
    s_addc_u32 s61, s21, 0
    s_mov_b32 s62, 7168
    s_mov_b32 s63, 0x20000
    v_mov_b32 v24, 148676
    s_branch L_wf_6
L_wf_6_r:
    s_sub_u32 s38, s38, 1
    s_cbranch_scc1 L_abort
L_wf_6:
    ds_read_b32 v25, v24
    s_waitcnt lgkmcnt(0)
    v_cmp_ne_u32 vcc, 4, v25
    s_cbranch_vccnz L_wf_6_r
    s_mov_b32 m0, 0
    s_nop 0
    buffer_load_dwordx4 v10, s[52:55], 0 offen offset:0 nt lds
    buffer_load_dwordx4 v11, s[52:55], 0 offen offset:1024 nt lds
    buffer_load_dwordx4 v12, s[52:55], 0 offen offset:2048 nt lds
    buffer_load_dwordx4 v13, s[52:55], 0 offen offset:3072 nt lds
    s_mov_b32 m0, 4096
    s_nop 0
    buffer_load_dwordx4 v14, s[52:55], 0 offen offset:0 nt lds
    buffer_load_dwordx4 v15, s[52:55], 0 offen offset:1024 nt lds
    buffer_load_dwordx4 v16, s[52:55], 0 offen offset:2048 nt lds
    s_mov_b32 m0, 7168
    s_nop 0
    buffer_load_dwordx4 v10, s[56:59], 0 offen offset:0 nt lds
    buffer_load_dwordx4 v11, s[56:59], 0 offen offset:1024 nt lds
    buffer_load_dwordx4 v12, s[56:59], 0 offen offset:2048 nt lds
    buffer_load_dwordx4 v13, s[56:59], 0 offen offset:3072 nt lds
    s_mov_b32 m0, 11264
    s_nop 0
    buffer_load_dwordx4 v14, s[56:59], 0 offen offset:0 nt lds
    buffer_load_dwordx4 v15, s[56:59], 0 offen offset:1024 nt lds
    buffer_load_dwordx4 v16, s[56:59], 0 offen offset:2048 nt lds
    s_mov_b32 m0, 16384
    s_mov_b32 s68, 0
    buffer_load_dwordx4 v9, s[60:63], s68 offen offset:0 nt lds
    buffer_load_dwordx4 v9, s[60:63], s68 offen offset:1024 nt lds
    buffer_load_dwordx4 v9, s[60:63], s68 offen offset:2048 nt lds
    buffer_load_dwordx4 v9, s[60:63], s68 offen offset:3072 nt lds
    s_mov_b32 m0, 20480
    s_mov_b32 s68, 4096
    buffer_load_dwordx4 v9, s[60:63], s68 offen offset:0 nt lds
    buffer_load_dwordx4 v9, s[60:63], s68 offen offset:1024 nt lds
    buffer_load_dwordx4 v9, s[60:63], s68 offen offset:2048 nt lds
    v_mov_b32 v23, 157
    s_mov_b64 exec, 1
    ds_write_b32 v22, v23
    s_mov_b64 exec, -1
    s_waitcnt vmcnt(7)
    v_mov_b32 v23, 170
    s_mov_b64 exec, 1
    ds_write_b32 v22, v23
    s_mov_b64 exec, -1
    s_waitcnt vmcnt(0)
    v_mov_b32 v23, 177
    s_mov_b64 exec, 1
    ds_write_b32 v22, v23
    s_mov_b64 exec, -1
L_loader_end:
    s_endpgm
L_compute:
    v_and_b32 v1, 15, v0
    v_lshrrev_b32 v2, 4, v0
    v_mov_b32 v3, 0x3ff
    v_mov_b32 v26, 148352
    s_mov_b64 s[66:67], -1
    s_mov_b32 s37, 2
    s_mov_b32 s39, 0
    v_mov_b32 v104, 0
    s_cmp_eq_u32 s30, 8
    s_cbranch_scc1 L_warm
    s_setprio 1
    s_cmp_lg_u32 s30, 4
    s_cbranch_scc1 L_noinit
    v_mov_b32 v4, 0
    v_mov_b32 v5, 0
    v_lshlrev_b32 v6, 3, v0
    v_add_u32 v6, 148352, v6
    ds_write_b64 v6, v[4:5]
    v_lshlrev_b32 v6, 2, v0
    v_add_u32 v6, 147200, v6
    ds_write_b32 v6, v4
L_noinit:
    s_waitcnt lgkmcnt(0)
    s_add_u32 s26, s26, 0xf800000
    s_addc_u32 s27, s27, 0
    s_load_dword s36, s[26:27], 0
    s_mov_b32 s56, s4
    s_mov_b32 s57, s5
    s_mov_b32 s58, 896
    s_mov_b32 s59, 0x20000
    s_cmp_ge_u32 s30, 4
    s_cbranch_scc1 L_noq
    v_lshlrev_b32 v4, 4, v0
    buffer_load_dwordx4 v[8:11], v4, s[56:59], 0 offen
    s_lshl_b32 s3, s29, 5
    v_lshl_add_u32 v5, v2, 3, s3
    buffer_load_dwordx2 v[20:21], v5, s[56:59], 0 offen
    s_barrier
    s_and_b32 s60, s29, 3
    s_mul_i32 s60, s60, 224
    v_lshl_add_u32 v27, v2, 3, s60
    v_add_u32 v27, 147456, v27
    v_lshrrev_b32 v6, 2, v1
    v_and_b32 v7, 3, v0
    v_lshl_add_u32 v12, v2, 2, v6
    v_lshrrev_b32 v13, 1, v12
    v_and_b32 v13, 3, v13
    v_lshlrev_b32 v13, 1, v13
    v_lshrrev_b32 v14, 1, v7
    s_lshl_b32 s3, s30, 1
    v_add_u32 v14, s3, v14
    v_xor_b32 v14, v14, v13
    v_lshlrev_b32 v14, 4, v14
    v_and_b32 v15, 1, v7
    v_lshl_add_u32 v14, v15, 3, v14
    v_lshl_add_u32 v28, v12, 7, v14
    v_add_u32 v28, 131072, v28
    s_waitcnt vmcnt(1)
    v_lshlrev_b32 v12, 16, v8
    v_and_b32 v13, 0xffff0000, v8
    v_lshlrev_b32 v14, 16, v9
    v_and_b32 v15, 0xffff0000, v9
    v_lshlrev_b32 v16, 16, v10
    v_and_b32 v17, 0xffff0000, v10
    v_lshlrev_b32 v18, 16, v11
    v_and_b32 v19, 0xffff0000, v11
    v_add_f32 v4, v12, v13
    v_add_f32 v5, v14, v15
    v_add_f32 v6, v16, v17
    v_add_f32 v7, v18, v19
    v_add_f32 v4, v4, v5
    v_add_f32 v6, v6, v7
    v_add_f32 v4, v4, v6
    s_nop 1
    v_add_f32_dpp v4, v4, v4 row_ror:8 row_mask:0xf bank_mask:0xf
    s_nop 1
    v_add_f32_dpp v4, v4, v4 row_ror:4 row_mask:0xf bank_mask:0xf
    s_nop 1
    v_add_f32_dpp v4, v4, v4 row_ror:2 row_mask:0xf bank_mask:0xf
    s_nop 1
    v_add_f32_dpp v4, v4, v4 row_ror:1 row_mask:0xf bank_mask:0xf
    v_mov_b32 v5, v4
    s_nop 1
    v_permlane32_swap_b32 v4, v5
    v_add_f32 v4, v4, v5
    v_mov_b32 v5, v4
    s_nop 1
    v_permlane16_swap_b32 v4, v5
    v_add_f32 v4, v4, v5
    v_mul_f32 v4, 0x3b124925, v4
    v_sub_f32 v32, v12, v4
    v_sub_f32 v33, v13, v4
    v_sub_f32 v34, v14, v4
    v_sub_f32 v35, v15, v4
    v_sub_f32 v36, v16, v4
    v_sub_f32 v37, v17, v4
    v_sub_f32 v38, v18, v4
    v_sub_f32 v39, v19, v4
    v_mul_f32 v5, v32, v32
    v_fmac_f32 v5, v33, v33
    v_fmac_f32 v5, v34, v34
    v_fmac_f32 v5, v35, v35
    v_fmac_f32 v5, v36, v36
    v_fmac_f32 v5, v37, v37
    v_fmac_f32 v5, v38, v38
    v_fmac_f32 v5, v39, v39
    v_cmp_gt_u32 vcc, 56, v0
    s_nop 1
    v_cndmask_b32 v5, 0, v5, vcc
    s_nop 1
    v_add_f32_dpp v5, v5, v5 row_ror:8 row_mask:0xf bank_mask:0xf
    s_nop 1
    v_add_f32_dpp v5, v5, v5 row_ror:4 row_mask:0xf bank_mask:0xf
    s_nop 1
    v_add_f32_dpp v5, v5, v5 row_ror:2 row_mask:0xf bank_mask:0xf
    s_nop 1
    v_add_f32_dpp v5, v5, v5 row_ror:1 row_mask:0xf bank_mask:0xf
    v_mov_b32 v6, v5
    s_nop 1
    v_permlane32_swap_b32 v5, v6
    v_add_f32 v5, v5, v6
    v_mov_b32 v6, v5
    s_nop 1
    v_permlane16_swap_b32 v5, v6
    v_add_f32 v5, v5, v6
    v_mul_f32 v5, 0x3b124925, v5
    v_cvt_pk_bf16_f32 v6, v5, v5
    v_lshlrev_b32 v5, 16, v6
    v_add_f32 v5, 0x3727c5ac, v5
    v_cvt_pk_bf16_f32 v6, v5, v5
    v_lshlrev_b32 v5, 16, v6
    v_sqrt_f32 v5, v5
    s_nop 0
    v_cvt_pk_bf16_f32 v6, v5, v5
    v_lshlrev_b32 v5, 16, v6
    v_rcp_f32 v5, v5
    v_cvt_pk_bf16_f32 v6, v4, v4
    v_lshlrev_b32 v4, 16, v6
    v_sub_f32 v32, v12, v4
    v_sub_f32 v33, v13, v4
    v_sub_f32 v34, v14, v4
    v_sub_f32 v35, v15, v4
    v_sub_f32 v36, v16, v4
    v_sub_f32 v37, v17, v4
    v_sub_f32 v38, v18, v4
    v_sub_f32 v39, v19, v4
    v_cvt_pk_bf16_f32 v8, v32, v33
    v_cvt_pk_bf16_f32 v9, v34, v35
    v_cvt_pk_bf16_f32 v10, v36, v37
    v_cvt_pk_bf16_f32 v11, v38, v39
    v_lshlrev_b32 v32, 16, v8
    v_and_b32 v33, 0xffff0000, v8
    v_lshlrev_b32 v34, 16, v9
    v_and_b32 v35, 0xffff0000, v9
    v_lshlrev_b32 v36, 16, v10
    v_and_b32 v37, 0xffff0000, v10
    v_lshlrev_b32 v38, 16, v11
    v_and_b32 v39, 0xffff0000, v11
    v_mul_f32 v32, v32, v5
    v_mul_f32 v33, v33, v5
    v_mul_f32 v34, v34, v5
    v_mul_f32 v35, v35, v5
    v_mul_f32 v36, v36, v5
    v_mul_f32 v37, v37, v5
    v_mul_f32 v38, v38, v5
    v_mul_f32 v39, v39, v5
    v_cvt_pk_bf16_f32 v8, v32, v33
    v_cvt_pk_bf16_f32 v9, v34, v35
    v_cvt_pk_bf16_f32 v10, v36, v37
    v_cvt_pk_bf16_f32 v11, v38, v39
    v_lshlrev_b32 v4, 4, v0
    v_add_u32 v4, 147456, v4
    s_and_b32 exec_lo, s66, 0xffffffff
    s_and_b32 exec_hi, s67, 0xffffff
    ds_write_b128 v4, v[8:11]
    s_mov_b64 exec, s[66:67]
    s_waitcnt lgkmcnt(0)
    ds_read_b64 v[32:33], v27 offset:0
    ds_read_b64 v[34:35], v27 offset:32
    ds_read_b64 v[36:37], v27 offset:64
    ds_read_b64 v[38:39], v27 offset:96
    ds_read_b64 v[40:41], v27 offset:128
    ds_read_b64 v[42:43], v27 offset:160
    ds_read_b64 v[44:45], v27 offset:192
    s_mul_i32 s31, s36, 1664525
    s_add_u32 s31, s31, 1013904223
    s_and_b32 s32, s31, 0x3ff
    s_bfe_u32 s33, s31, 0xa000a
    s_bfe_u32 s34, s31, 0xa0014
    s_mul_i32 s3, s31, 0x9e3779b1
    s_lshr_b32 s3, s3, 24
    s_lshl_b32 s3, s3, 2
    s_lshr_b32 s35, s31, 30
    s_or_b32 s35, s35, s3
    s_branch L_wl_7
L_wl_7_r:
    s_sub_u32 s38, s38, 1
    s_cbranch_scc1 L_abort
L_wl_7:
    ds_read_b32 v4, v26
    s_waitcnt lgkmcnt(0)
    v_cmp_gt_u32 vcc, 14, v4
    s_cbranch_vccnz L_wl_7_r
    ds_read_b64_tr_b16 v[48:49], v28 offset:0
    ds_read_b64_tr_b16 v[50:51], v28 offset:2048
    ds_read_b64_tr_b16 v[52:53], v28 offset:4096
    ds_read_b64_tr_b16 v[54:55], v28 offset:6144
    ds_read_b64_tr_b16 v[56:57], v28 offset:8192
    ds_read_b64_tr_b16 v[58:59], v28 offset:10240
    ds_read_b64_tr_b16 v[60:61], v28 offset:12288
    v_mov_b32 v64, 0
    v_mov_b32 v65, 0
    v_mov_b32 v66, 0
    v_mov_b32 v67, 0
    s_lshl_b32 s60, s28, 13
    s_lshl_b32 s61, s29, 8
    s_add_u32 s60, s60, s61
    s_lshl_b32 s61, s30, 6
    s_add_u32 s60, s60, s61
    s_add_u32 s60, s60, 131072
    v_lshl_add_u32 v4, v2, 4, s60
    s_lshl_b32 s61, s30, 2
    s_add_u32 s61, s61, 148368
    v_mov_b32 v5, s61
    s_waitcnt lgkmcnt(0)
    v_mfma_f32_16x16x16_bf16 v[64:67], v[48:49], v[32:33], v[64:67]
    v_mfma_f32_16x16x16_bf16 v[64:67], v[50:51], v[34:35], v[64:67]
    v_mfma_f32_16x16x16_bf16 v[64:67], v[52:53], v[36:37], v[64:67]
    v_mfma_f32_16x16x16_bf16 v[64:67], v[54:55], v[38:39], v[64:67]
    v_mfma_f32_16x16x16_bf16 v[64:67], v[56:57], v[40:41], v[64:67]
    v_mfma_f32_16x16x16_bf16 v[64:67], v[58:59], v[42:43], v[64:67]
    v_mfma_f32_16x16x16_bf16 v[64:67], v[60:61], v[44:45], v[64:67]
    v_add_u32 v104, 0x400000, v4
    s_nop 6
    v_bfi_b32 v100, v3, s32, v64
    v_bfi_b32 v101, v3, s33, v65
    v_bfi_b32 v102, v3, s34, v66
    v_bfi_b32 v103, v3, s35, v67
    s_mov_b32 s68, 0x00010001
    s_mov_b32 s69, 0x00010001
    s_and_b32 exec_lo, s66, 0x10001
    s_and_b32 exec_hi, s67, 0x10001
    global_store_dwordx4 v4, v[100:103], s[26:27]
    s_mov_b64 exec, s[66:67]
    v_mov_b32 v6, 1
    s_and_b64 exec, s[66:67], 1
    ds_write_b32 v5, v6
    s_mov_b64 exec, s[66:67]
    s_branch L_agather
L_noq:
    s_mov_b32 s68, 0
    s_mov_b32 s69, 0
    s_barrier
    s_waitcnt lgkmcnt(0)
    s_mul_i32 s31, s36, 1664525
    s_add_u32 s31, s31, 1013904223
    s_and_b32 s32, s31, 0x3ff
    s_bfe_u32 s33, s31, 0xa000a
    s_bfe_u32 s34, s31, 0xa0014
    s_mul_i32 s3, s31, 0x9e3779b1
    s_lshr_b32 s3, s3, 24
    s_lshl_b32 s3, s3, 2
    s_lshr_b32 s35, s31, 30
    s_or_b32 s35, s35, s3
    s_cmp_lg_u32 s30, 5
    s_cbranch_scc1 L_noid
    s_getreg_b32 s60, hwreg(HW_REG_XCC_ID, 0, 4)
    s_lshl_b32 s60, s60, 10
    v_mov_b32 v4, s60
    v_mov_b32 v5, s60
    v_mov_b32 v6, s60
    v_mov_b32 v7, s60
    v_bfi_b32 v8, v3, s32, v4
    v_bfi_b32 v9, v3, s33, v5
    v_bfi_b32 v10, v3, s34, v6
    v_bfi_b32 v11, v3, s35, v7
    s_lshl_b32 s60, s28, 5
    s_add_u32 s60, s60, s29
    s_lshl_b32 s60, s60, 4
    s_add_u32 s60, s60, 4096
    v_mov_b32 v4, s60
    v_add_u32 v5, 0x400000, v4
    s_and_b64 exec, s[66:67], 1
    global_store_dwordx4 v4, v[8:11], s[26:27]
    global_store_dwordx4 v5, v[8:11], s[26:27] sc1
    s_mov_b64 exec, s[66:67]
L_noid:
L_agather:
    s_lshl_b32 s60, s28, 13
    s_lshl_b32 s61, s30, 10
    s_add_u32 s60, s60, s61
    s_add_u32 s60, s60, 131072
    v_lshl_add_u32 v28, v0, 4, s60
    v_and_b32 v5, 3, v0
    v_lshlrev_b32 v5, 2, v5
    v_add_u32 v5, 148368, v5
    s_branch L_wf_8
L_wf_8_r:
    s_sub_u32 s38, s38, 1
    s_cbranch_scc1 L_abort
L_wf_8:
    ds_read_b32 v6, v5
    s_waitcnt lgkmcnt(0)
    v_cmp_ne_u32 vcc, 1, v6
    s_cbranch_vccnz L_wf_8_r
    s_sleep 32
    s_mov_b32 s64, 0
    s_lshl_b32 s60, s28, 9
    s_add_u32 s60, s60, 4096
    v_and_b32 v4, 31, v0
    v_lshl_add_u32 v13, v4, 4, s60
    v_mov_b32 v16, s32
    v_mov_b32 v17, s33
    v_mov_b32 v18, s34
    v_mov_b32 v19, s35
    s_cmp_eq_u32 s30, 4
    s_cselect_b32 s65, -1, 0
    s_branch L_ag_9
L_ag_9_r:
    s_sub_u32 s38, s38, 1
    s_cbranch_scc1 L_abort
    s_add_u32 s64, s64, 1
    s_cmp_lt_u32 s64, 5
    s_cbranch_scc1 L_ag_9
    s_or_b32 s3, s68, s69
    s_cbranch_scc0 L_pg_10
    s_mov_b32 exec_lo, s68
    s_mov_b32 exec_hi, s69
    global_store_dwordx4 v104, v[100:103], s[26:27] sc1
    s_mov_b64 exec, s[66:67]
    s_mov_b32 s68, 0
    s_mov_b32 s69, 0
L_pg_10:
    v_xor_b32 v28, 0x400000, v28
    v_xor_b32 v13, 0x400000, v13
L_ag_9:
    global_load_dwordx4 v[4:7], v28, s[26:27] sc1
    s_mov_b32 exec_lo, s65
    s_mov_b32 exec_hi, s65
    global_load_dwordx4 v[16:19], v13, s[26:27] sc1
    s_mov_b64 exec, s[66:67]
    s_waitcnt vmcnt(0)
    s_cmp_eq_u32 s65, 0
    s_cbranch_scc1 L_ag_9_n
    v_xor_b32 v40, s32, v16
    v_xor_b32 v41, s33, v17
    v_xor_b32 v42, s34, v18
    v_xor_b32 v43, s35, v19
    v_or3_b32 v12, v40, v41, v42
    v_or_b32 v12, v12, v43
    v_and_b32 v12, v3, v12
    v_cmp_ne_u32 vcc, 0, v12
    s_cbranch_vccnz L_ag_9_n
    s_getreg_b32 s60, hwreg(HW_REG_XCC_ID, 0, 4)
    s_lshl_b32 s60, s60, 10
    v_cmp_ne_u32 vcc, s60, v40
    s_mov_b32 s61, 1
    s_cmp_lg_u64 vcc, 0
    s_cmov_b32 s61, 2
    v_mov_b32 v14, 148672
    v_mov_b32 v15, s61
    s_and_b64 exec, s[66:67], 1
    ds_write_b32 v14, v15
    s_mov_b64 exec, s[66:67]
    s_mov_b32 s65, 0
L_ag_9_n:
    v_xor_b32 v8, s32, v4
    v_xor_b32 v9, s33, v5
    v_xor_b32 v10, s34, v6
    v_xor_b32 v11, s35, v7
    v_or3_b32 v12, v8, v9, v10
    v_or_b32 v12, v12, v11
    v_and_b32 v12, v3, v12
    v_cmp_ne_u32 vcc, 0, v12
    s_cbranch_vccnz L_ag_9_r
    s_cmp_lg_u32 s65, 0
    s_cbranch_scc1 L_ag_9_r
L_afterA:
    v_permlane32_swap_b32 v8, v9
    v_permlane32_swap_b32 v10, v11
    v_add_f32 v8, v8, v9
    v_add_f32 v10, v10, v11
    s_nop 1
    v_permlane16_swap_b32 v8, v10
    v_add_f32 v8, v8, v10
    v_cvt_pk_bf16_f32 v8, v8, v8
    v_and_b32 v4, 1, v2
    v_lshlrev_b32 v4, 1, v4
    v_lshrrev_b32 v5, 1, v2
    v_or_b32 v4, v4, v5
    v_lshl_add_u32 v4, v1, 2, v4
    v_lshlrev_b32 v4, 1, v4
    s_and_b32 s3, s30, 3
    s_lshl_b32 s3, s3, 7
    s_lshr_b32 s60, s30, 2
    s_mul_i32 s60, s60, 576
    s_add_u32 s3, s3, s60
    s_add_u32 s3, s3, 145408
    v_add_u32 v4, s3, v4
    ds_write_b16 v4, v8
    s_lshl_b32 s61, s30, 2
    s_add_u32 s62, s61, 148416
    v_mov_b32 v5, s62
    v_mov_b32 v6, 1
    s_and_b64 exec, s[66:67], 1
    ds_write_b32 v5, v6
    s_mov_b64 exec, s[66:67]
    v_mov_b32 v5, 148672
    s_branch L_md_11
L_md_11_r:
    s_sub_u32 s38, s38, 1
    s_cbranch_scc1 L_abort
L_md_11:
    ds_read_b32 v6, v5
    s_waitcnt lgkmcnt(0)
    v_cmp_eq_u32 vcc, 0, v6
    s_cbranch_vccnz L_md_11_r
    v_readfirstlane_b32 s37, v6
    s_nop 0
    s_cmp_eq_u32 s37, 1
    s_cbranch_scc1 L_loc_12
    s_or_b32 s3, s68, s69
    s_cbranch_scc0 L_pg_13
    s_mov_b32 exec_lo, s68
    s_mov_b32 exec_hi, s69
    s_cbranch_execz L_g_14
    global_store_dwordx4 v104, v[100:103], s[26:27] sc1
L_g_14:
    s_mov_b64 exec, s[66:67]
    s_mov_b32 s68, 0
    s_mov_b32 s69, 0
L_pg_13:
L_loc_12:
    v_xor_b32 v5, v2, v1
    v_lshlrev_b32 v5, 4, v5
    v_lshl_add_u32 v5, v1, 9, v5
    s_lshl_b32 s3, s30, 13
    s_add_u32 s3, s3, 0
    v_add_u32 v5, s3, v5
    s_lshl_b32 s60, s30, 3
    s_add_u32 s60, s60, 22
    v_and_b32 v29, 7, v0
    v_lshlrev_b32 v29, 2, v29
    s_branch L_wl_15
L_wl_15_r:
    s_sub_u32 s38, s38, 1
    s_cbranch_scc1 L_abort
L_wl_15:
    ds_read_b32 v4, v26
    s_waitcnt lgkmcnt(0)
    v_cmp_gt_u32 vcc, s60, v4
    s_cbranch_vccnz L_wl_15_r
    ds_read_b128 v[64:67], v5
    v_xor_b32 v6, 64, v5
    ds_read_b128 v[68:71], v6
    v_xor_b32 v6, 128, v5
    ds_read_b128 v[72:75], v6
    v_xor_b32 v6, 192, v5
    ds_read_b128 v[76:79], v6
    v_xor_b32 v6, 256, v5
    ds_read_b128 v[80:83], v6
    v_xor_b32 v6, 320, v5
    ds_read_b128 v[84:87], v6
    v_xor_b32 v6, 384, v5
    ds_read_b128 v[88:91], v6
    v_xor_b32 v6, 448, v5
    ds_read_b128 v[92:95], v6
    v_add_u32 v5, 148416, v29
    v_and_b32 v7, 1, v1
    v_mul_u32_u24 v7, 576, v7
    v_lshl_add_u32 v7, v2, 4, v7
    v_add_u32 v7, 145408, v7
    s_branch L_wf_16
L_wf_16_r:
    s_sub_u32 s38, s38, 1
    s_cbranch_scc1 L_abort
L_wf_16:
    ds_read_b32 v6, v5
    s_waitcnt lgkmcnt(0)
    v_cmp_ne_u32 vcc, 1, v6
    s_cbranch_vccnz L_wf_16_r
    ds_read_b128 v[32:35], v7 offset:0
    ds_read_b128 v[36:39], v7 offset:64
    ds_read_b128 v[40:43], v7 offset:128
    ds_read_b128 v[44:47], v7 offset:192
    ds_read_b128 v[48:51], v7 offset:256
    ds_read_b128 v[52:55], v7 offset:320
    ds_read_b128 v[56:59], v7 offset:384
    ds_read_b128 v[60:63], v7 offset:448
    v_mov_b32 v96, 0
    v_mov_b32 v97, 0
    v_mov_b32 v98, 0
    v_mov_b32 v99, 0
    s_waitcnt lgkmcnt(7)
    s_nop 0
    v_mfma_f32_16x16x32_bf16 v[96:99], v[32:35], v[64:67], v[96:99]
    s_waitcnt lgkmcnt(6)
    v_mfma_f32_16x16x32_bf16 v[96:99], v[36:39], v[68:71], v[96:99]
    s_waitcnt lgkmcnt(5)
    v_mfma_f32_16x16x32_bf16 v[96:99], v[40:43], v[72:75], v[96:99]
    s_waitcnt lgkmcnt(4)
    v_mfma_f32_16x16x32_bf16 v[96:99], v[44:47], v[76:79], v[96:99]
    s_waitcnt lgkmcnt(3)
    v_mfma_f32_16x16x32_bf16 v[96:99], v[48:51], v[80:83], v[96:99]
    s_waitcnt lgkmcnt(2)
    v_mfma_f32_16x16x32_bf16 v[96:99], v[52:55], v[84:87], v[96:99]
    s_waitcnt lgkmcnt(1)
    v_mfma_f32_16x16x32_bf16 v[96:99], v[56:59], v[88:91], v[96:99]
    s_waitcnt lgkmcnt(0)
    v_mfma_f32_16x16x32_bf16 v[96:99], v[60:63], v[92:95], v[96:99]
    s_nop 7
    v_cvt_pk_bf16_f32 v4, v96, v97
    v_lshlrev_b32 v8, 16, v4
    v_and_b32 v9, 0xffff0000, v4
    v_mov_b32 v10, v8
    v_mov_b32 v11, v9
    s_nop 0
    v_max_f32_dpp v10, v10, v10 row_ror:8 row_mask:0xf bank_mask:0xf
    v_max_f32_dpp v11, v11, v11 row_ror:8 row_mask:0xf bank_mask:0xf
    s_nop 0
    v_max_f32_dpp v10, v10, v10 row_ror:4 row_mask:0xf bank_mask:0xf
    v_max_f32_dpp v11, v11, v11 row_ror:4 row_mask:0xf bank_mask:0xf
    s_nop 0
    v_max_f32_dpp v10, v10, v10 row_ror:2 row_mask:0xf bank_mask:0xf
    v_max_f32_dpp v11, v11, v11 row_ror:2 row_mask:0xf bank_mask:0xf
    s_nop 0
    v_max_f32_dpp v10, v10, v10 row_ror:1 row_mask:0xf bank_mask:0xf
    v_max_f32_dpp v11, v11, v11 row_ror:1 row_mask:0xf bank_mask:0xf
    s_lshl_b32 s61, s30, 3
    s_add_u32 s62, s61, 148480
    v_mov_b32 v5, s62
    s_lshl_b32 s61, s30, 2
    s_add_u32 s62, s61, 148448
    v_mov_b32 v6, s62
    v_mov_b32 v7, 1
    s_and_b64 exec, s[66:67], 1
    ds_write_b64 v5, v[10:11]
    ds_write_b32 v6, v7
    s_mov_b64 exec, s[66:67]
    v_add_u32 v5, 148448, v29
    s_branch L_wf_17
L_wf_17_r:
    s_sub_u32 s38, s38, 1
    s_cbranch_scc1 L_abort
L_wf_17:
    ds_read_b32 v6, v5
    s_waitcnt lgkmcnt(0)
    v_cmp_ne_u32 vcc, 1, v6
    s_cbranch_vccnz L_wf_17_r
    v_lshlrev_b32 v5, 1, v29
    v_add_u32 v5, 148480, v5
    ds_read_b64 v[10:11], v5
    s_waitcnt lgkmcnt(0)
    v_max_f32_dpp v10, v10, v10 row_ror:4 row_mask:0xf bank_mask:0xf
    v_max_f32_dpp v11, v11, v11 row_ror:4 row_mask:0xf bank_mask:0xf
    s_nop 0
    v_max_f32_dpp v10, v10, v10 row_ror:2 row_mask:0xf bank_mask:0xf
    v_max_f32_dpp v11, v11, v11 row_ror:2 row_mask:0xf bank_mask:0xf
    s_nop 0
    v_max_f32_dpp v10, v10, v10 row_ror:1 row_mask:0xf bank_mask:0xf
    v_max_f32_dpp v11, v11, v11 row_ror:1 row_mask:0xf bank_mask:0xf
    v_sub_f32 v12, v8, v10
    v_sub_f32 v13, v9, v11
    v_mul_f32 v12, 0x3db8aa3b, v12
    v_mul_f32 v13, 0x3db8aa3b, v13
    v_exp_f32 v12, v12
    v_exp_f32 v13, v13
    s_nop 0
    v_cvt_pk_bf16_f32 v14, v12, v13
    v_add_f32_dpp v12, v12, v12 row_ror:8 row_mask:0xf bank_mask:0xf
    v_add_f32_dpp v13, v13, v13 row_ror:8 row_mask:0xf bank_mask:0xf
    s_nop 0
    v_add_f32_dpp v12, v12, v12 row_ror:4 row_mask:0xf bank_mask:0xf
    v_add_f32_dpp v13, v13, v13 row_ror:4 row_mask:0xf bank_mask:0xf
    s_nop 0
    v_add_f32_dpp v12, v12, v12 row_ror:2 row_mask:0xf bank_mask:0xf
    v_add_f32_dpp v13, v13, v13 row_ror:2 row_mask:0xf bank_mask:0xf
    s_nop 0
    v_add_f32_dpp v12, v12, v12 row_ror:1 row_mask:0xf bank_mask:0xf
    v_add_f32_dpp v13, v13, v13 row_ror:1 row_mask:0xf bank_mask:0xf
    v_lshrrev_b32 v4, 2, v1
    v_lshlrev_b32 v4, 3, v4
    v_and_b32 v5, 3, v1
    v_add_u32 v4, v4, v5
    s_lshr_b32 s60, s30, 1
    s_lshl_b32 s60, s60, 5
    s_and_b32 s61, s30, 1
    s_lshl_b32 s61, s61, 2
    s_add_u32 s60, s60, s61
    v_add_u32 v4, s60, v4
    v_lshlrev_b32 v4, 1, v4
    v_add_u32 v4, 146560, v4
    s_lshl_b32 s61, s30, 3
    s_add_u32 s62, s61, 148608
    v_mov_b32 v5, s62
    s_lshl_b32 s61, s30, 2
    s_add_u32 s62, s61, 148544
    v_mov_b32 v6, s62
    v_mov_b32 v7, 1
    s_and_b32 exec_lo, s66, 0xffff
    s_and_b32 exec_hi, s67, 0x0
    ds_write_b16 v4, v14
    ds_write_b16_d16_hi v4, v14 offset:320
    s_and_b64 exec, s[66:67], 1
    ds_write_b64 v5, v[12:13]
    ds_write_b32 v6, v7
    s_mov_b64 exec, s[66:67]
    v_add_u32 v5, 148544, v29
    s_branch L_wf_18
L_wf_18_r:
    s_sub_u32 s38, s38, 1
    s_cbranch_scc1 L_abort
L_wf_18:
    ds_read_b32 v6, v5
    s_waitcnt lgkmcnt(0)
    v_cmp_ne_u32 vcc, 1, v6
    s_cbranch_vccnz L_wf_18_r
    s_cmp_lg_u32 s30, 0
    s_cbranch_scc1 L_nostat
    v_lshlrev_b32 v5, 1, v29
    v_add_u32 v5, 148608, v5
    ds_read_b64 v[12:13], v5
    s_waitcnt lgkmcnt(0)
    v_add_f32_dpp v12, v12, v12 row_ror:4 row_mask:0xf bank_mask:0xf
    v_add_f32_dpp v13, v13, v13 row_ror:4 row_mask:0xf bank_mask:0xf
    s_nop 0
    v_add_f32_dpp v12, v12, v12 row_ror:2 row_mask:0xf bank_mask:0xf
    v_add_f32_dpp v13, v13, v13 row_ror:2 row_mask:0xf bank_mask:0xf
    s_nop 0
    v_add_f32_dpp v12, v12, v12 row_ror:1 row_mask:0xf bank_mask:0xf
    v_add_f32_dpp v13, v13, v13 row_ror:1 row_mask:0xf bank_mask:0xf
    v_mov_b32 v4, v10
    v_mov_b32 v5, v12
    v_mov_b32 v6, v11
    v_mov_b32 v7, v13
    v_bfi_b32 v8, v3, s32, v4
    v_bfi_b32 v9, v3, s33, v5
    v_bfi_b32 v10, v3, s34, v6
    v_bfi_b32 v11, v3, s35, v7
    s_lshl_b32 s60, s28, 5
    s_add_u32 s60, s60, s29
    s_lshl_b32 s60, s60, 4
    s_add_u32 s60, s60, 8192
    v_mov_b32 v4, s60
    s_and_b64 exec, s[66:67], 1
    s_cbranch_execz L_gst_19_b
    s_cmp_eq_u32 s37, 1
    s_cbranch_scc0 L_gst_19
    global_store_dwordx4 v4, v[8:11], s[26:27]
L_gst_19_b:
    s_mov_b64 exec, s[66:67]
L_nostat:
L_pvstart:
    v_and_b32 v4, 1, v1
    v_mul_u32_u24 v4, 320, v4
    v_lshl_add_u32 v4, v2, 4, v4
    v_add_u32 v4, 146560, v4
    v_lshlrev_b32 v5, 4, v2
    v_add_u32 v5, 147200, v5
    v_and_b32 v6, 2, v1
    v_cmp_eq_u32 vcc, 0, v6
    s_nop 1
    v_cndmask_b32 v30, v5, v4, vcc
    v_cndmask_b32 v31, v4, v5, vcc
    v_lshrrev_b32 v6, 2, v1
    v_and_b32 v7, 3, v0
    v_lshl_add_u32 v8, v2, 2, v6
    v_and_b32 v9, 7, v8
    v_lshlrev_b32 v9, 1, v9
    v_lshrrev_b32 v10, 1, v7
    s_lshl_b32 s3, s30, 2
    v_add_u32 v10, s3, v10
    v_xor_b32 v10, v10, v9
    v_lshlrev_b32 v10, 4, v10
    v_and_b32 v11, 1, v7
    v_lshl_add_u32 v10, v11, 3, v10
    v_lshl_add_u32 v16, v8, 9, v10
    v_add_u32 v16, 65536, v16
    v_xor_b32 v17, 32, v16
    v_and_b32 v4, 1, v1
    v_lshlrev_b32 v4, 4, v4
    v_lshrrev_b32 v5, 1, v1
    v_and_b32 v5, 1, v5
    v_add_u32 v4, v4, v5
    s_lshl_b32 s3, s30, 1
    v_add_u32 v4, s3, v4
    v_mul_u32_u24 v4, 2176, v4
    v_lshl_add_u32 v4, v2, 4, v4
    s_mul_i32 s60, s28, 69632
    s_lshl_b32 s61, s29, 6
    s_add_u32 s60, s60, s61
    s_add_u32 s60, s60, 196608
    v_add_u32 v18, s60, v4
    v_mov_b32 v96, 0
    v_mov_b32 v97, 0
    v_mov_b32 v98, 0
    v_mov_b32 v99, 0
    s_lshl_b32 s60, s28, 9
    s_add_u32 s60, s60, 8192
    v_lshl_add_u32 v19, v1, 4, s60
    ds_read_b128 v[32:35], v30 offset:0
    ds_read_b128 v[36:39], v31 offset:0
    ds_read_b128 v[40:43], v30 offset:64
    ds_read_b128 v[44:47], v31 offset:64
    ds_read_b128 v[48:51], v30 offset:128
    ds_read_b128 v[52:55], v31 offset:128
    ds_read_b128 v[56:59], v30 offset:192
    ds_read_b128 v[60:63], v31 offset:192
    s_mov_b32 s65, s39
L_wc_20:
    s_cmp_ge_u32 s65, 94
    s_cbranch_scc1 L_wc_20_ok
    ds_read_b32 v4, v26
    s_sub_u32 s38, s38, 1
    s_cbranch_scc1 L_abort
    s_waitcnt lgkmcnt(0)
    v_readfirstlane_b32 s65, v4
    s_branch L_wc_20
L_wc_20_ok:
    ds_read_b64_tr_b16 v[64:65], v16 offset:0
    ds_read_b64_tr_b16 v[66:67], v16 offset:8192
    ds_read_b64_tr_b16 v[68:69], v17 offset:0
    ds_read_b64_tr_b16 v[70:71], v17 offset:8192
    s_waitcnt lgkmcnt(2)
    v_mfma_f32_16x16x32_bf16 v[96:99], v[64:67], v[32:35], v[96:99]
    s_waitcnt lgkmcnt(0)
    v_mfma_f32_16x16x32_bf16 v[96:99], v[68:71], v[36:39], v[96:99]
L_wc_21:
    s_cmp_ge_u32 s65, 110
    s_cbranch_scc1 L_wc_21_ok
    ds_read_b32 v4, v26
    s_sub_u32 s38, s38, 1
    s_cbranch_scc1 L_abort
    s_waitcnt lgkmcnt(0)
    v_readfirstlane_b32 s65, v4
    s_branch L_wc_21
L_wc_21_ok:
    ds_read_b64_tr_b16 v[72:73], v16 offset:16384
    ds_read_b64_tr_b16 v[74:75], v16 offset:24576
    ds_read_b64_tr_b16 v[76:77], v17 offset:16384
    ds_read_b64_tr_b16 v[78:79], v17 offset:24576
    s_waitcnt lgkmcnt(2)
    v_mfma_f32_16x16x32_bf16 v[96:99], v[72:75], v[40:43], v[96:99]
    s_waitcnt lgkmcnt(0)
    v_mfma_f32_16x16x32_bf16 v[96:99], v[76:79], v[44:47], v[96:99]
L_wc_22:
    s_cmp_ge_u32 s65, 126
    s_cbranch_scc1 L_wc_22_ok
    ds_read_b32 v4, v26
    s_sub_u32 s38, s38, 1
    s_cbranch_scc1 L_abort
    s_waitcnt lgkmcnt(0)
    v_readfirstlane_b32 s65, v4
    s_branch L_wc_22
L_wc_22_ok:
    v_add_u32 v16, 0x8000, v16
    v_add_u32 v17, 0x8000, v17
    ds_read_b64_tr_b16 v[64:65], v16 offset:0
    ds_read_b64_tr_b16 v[66:67], v16 offset:8192
    ds_read_b64_tr_b16 v[68:69], v17 offset:0
    ds_read_b64_tr_b16 v[70:71], v17 offset:8192
    s_waitcnt lgkmcnt(2)
    v_mfma_f32_16x16x32_bf16 v[96:99], v[64:67], v[48:51], v[96:99]
    s_waitcnt lgkmcnt(0)
    v_mfma_f32_16x16x32_bf16 v[96:99], v[68:71], v[52:55], v[96:99]
    s_cmp_ge_u32 s30, 4
    s_cbranch_scc1 L_nos_23
    s_cbranch_execz L_g_24
    global_load_dwordx4 v[80:83], v19, s[26:27] sc1
    global_load_dwordx4 v[84:87], v19, s[26:27] offset:256 sc1
L_g_24:
L_nos_23:
L_wc_25:
    s_cmp_ge_u32 s65, 142
    s_cbranch_scc1 L_wc_25_ok
    ds_read_b32 v4, v26
    s_sub_u32 s38, s38, 1
    s_cbranch_scc1 L_abort
    s_waitcnt lgkmcnt(0)
    v_readfirstlane_b32 s65, v4
    s_branch L_wc_25
L_wc_25_ok:
    ds_read_b64_tr_b16 v[72:73], v16 offset:16384
    ds_read_b64_tr_b16 v[74:75], v16 offset:24576
    ds_read_b64_tr_b16 v[76:77], v17 offset:16384
    ds_read_b64_tr_b16 v[78:79], v17 offset:24576
    s_waitcnt lgkmcnt(2)
    v_mfma_f32_16x16x32_bf16 v[96:99], v[72:75], v[56:59], v[96:99]
    s_waitcnt lgkmcnt(0)
    v_mfma_f32_16x16x32_bf16 v[96:99], v[76:79], v[60:63], v[96:99]
    s_nop 7
    v_bfi_b32 v8, v3, s32, v96
    v_bfi_b32 v9, v3, s33, v97
    v_bfi_b32 v10, v3, s34, v98
    v_bfi_b32 v11, v3, s35, v99
    s_and_b32 exec_lo, s66, 0xf000f
    s_and_b32 exec_hi, s67, 0xf000f
    s_cbranch_execz L_gst_26_b
    s_cmp_eq_u32 s37, 1
    s_cbranch_scc0 L_gst_26
    global_store_dwordx4 v18, v[8:11], s[26:27]
L_gst_26_b:
    s_mov_b64 exec, s[66:67]
    s_cmp_lt_u32 s30, 4
    s_cbranch_scc1 L_tail
    s_cmp_lt_u32 s29, 28
    s_cbranch_scc1 L_touch
    s_cmp_lt_u32 s30, 7
    s_cbranch_scc1 L_red
    s_endpgm
L_touch:
    s_cmp_lg_u32 s30, 4
    s_cbranch_scc1 L_end
    s_mul_i32 s60, s28, 103936
    s_mul_i32 s61, s29, 3712
    s_add_u32 s60, s60, s61
    s_add_u32 s60, s60, 786432
    v_and_b32 v4, 31, v0
    v_lshlrev_b32 v4, 7, v4
    v_add_u32 v4, s60, v4
    v_lshlrev_b32 v5, 7, v1
    s_mul_i32 s60, s28, 53760
    s_mul_i32 s61, s29, 1920
    s_add_u32 s60, s60, s61
    s_add_u32 s60, s60, 1638400
    v_add_u32 v6, s60, v5
    v_and_b32 v5, 0x380, v5
    s_lshl_b32 s61, s29, 10
    s_add_u32 s60, s61, 45056
    v_add_u32 v7, s60, v5
    s_lshl_b32 s60, s28, 9
    s_add_u32 s60, s60, 12288
    v_and_b32 v8, 0x180, v5
    v_add_u32 v8, s60, v8
    v_cmp_lt_u32 vcc, 31, v0
    s_nop 1
    v_cndmask_b32 v4, v4, v6, vcc
    v_cmp_lt_u32 vcc, 47, v0
    s_nop 1
    v_cndmask_b32 v4, v4, v7, vcc
    v_cmp_lt_u32 vcc, 55, v0
    s_nop 1
    v_cndmask_b32 v4, v4, v8, vcc
    s_branch L_wl_27
L_wl_27_r:
    s_sub_u32 s38, s38, 1
    s_cbranch_scc1 L_abort
L_wl_27:
    ds_read_b32 v16, v26
    s_waitcnt lgkmcnt(0)
    v_cmp_gt_u32 vcc, 157, v16
    s_cbranch_vccnz L_wl_27_r
    s_mov_b32 exec_lo, 0x0fffffff
    s_mov_b32 exec_hi, 0x0f000000
    global_load_dword v5, v4, s[26:27]
    s_lshl_b32 s60, s29, 5
    v_mov_b32 v6, s60
    s_mov_b64 exec, 1
    global_load_dword v7, v6, s[22:23]
    s_endpgm
L_tail:
    s_mul_i32 s60, s28, 69632
    s_mul_i32 s61, s29, 2176
    s_add_u32 s60, s60, s61
    s_add_u32 s60, s60, 196608
    v_lshlrev_b32 v28, 6, v1
    v_lshl_add_u32 v28, v2, 4, v28
    v_add_u32 v29, s60, v28
    s_waitcnt vmcnt(1)
L_sg_28:
    v_xor_b32 v32, s32, v80
    v_xor_b32 v33, s33, v81
    v_xor_b32 v34, s34, v82
    v_xor_b32 v35, s35, v83
    v_xor_b32 v36, s32, v84
    v_xor_b32 v37, s33, v85
    v_xor_b32 v38, s34, v86
    v_xor_b32 v39, s35, v87
    v_or3_b32 v12, v32, v33, v34
    v_or3_b32 v12, v12, v35, v36
    v_or3_b32 v12, v12, v37, v38
    v_or_b32 v12, v12, v39
    v_and_b32 v12, v3, v12
    v_cmp_ne_u32 vcc, 0, v12
    s_cbranch_vccz L_sg_28_ok
    s_sub_u32 s38, s38, 1
    s_cbranch_scc1 L_abort
    global_load_dwordx4 v[80:83], v19, s[26:27] sc1
    global_load_dwordx4 v[84:87], v19, s[26:27] offset:256 sc1
    s_waitcnt vmcnt(0)
    s_branch L_sg_28
L_sg_28_ok:
    s_cmp_lt_u32 s29, 16
    s_cbranch_scc1 L_h0_29
    v_mov_b32 v32, v34
    v_mov_b32 v33, v35
    v_mov_b32 v36, v38
    v_mov_b32 v37, v39
L_h0_29:
    s_mul_i32 s63, s30, 7
    s_mov_b32 s40, 0x10001
    s_mov_b32 s41, 0x10001
    s_mov_b32 s42, 0x20002
    s_mov_b32 s43, 0x20002
    s_mov_b32 s44, 0x40004
    s_mov_b32 s45, 0x40004
    s_mov_b32 s46, 0x80008
    s_mov_b32 s47, 0x80008
    s_mov_b32 s48, 0x100010
    s_mov_b32 s49, 0x100010
    s_mov_b32 s50, 0x200020
    s_mov_b32 s51, 0x200020
    s_mov_b32 s52, 0x400040
    s_mov_b32 s53, 0x400040
    s_mov_b32 s54, 0x800080
    s_mov_b32 s55, 0x800080
    v_max_f32 v16, v32, v36
    s_nop 1
    v_max_f32_dpp v16, v16, v16 row_ror:8 row_mask:0xf bank_mask:0xf
    s_nop 1
    v_max_f32_dpp v16, v16, v16 row_ror:4 row_mask:0xf bank_mask:0xf
    s_nop 1
    v_max_f32_dpp v16, v16, v16 row_ror:2 row_mask:0xf bank_mask:0xf
    s_nop 1
    v_max_f32_dpp v16, v16, v16 row_ror:1 row_mask:0xf bank_mask:0xf
    v_sub_f32 v22, v32, v16
    v_sub_f32 v23, v36, v16
    v_mul_f32 v22, 0x3db8aa3b, v22
    v_mul_f32 v23, 0x3db8aa3b, v23
    v_exp_f32 v22, v22
    v_exp_f32 v23, v23
    v_mul_f32 v17, v22, v33
    v_fmac_f32 v17, v23, v37
    s_nop 1
    v_add_f32_dpp v17, v17, v17 row_ror:8 row_mask:0xf bank_mask:0xf
    s_nop 1
    v_add_f32_dpp v17, v17, v17 row_ror:4 row_mask:0xf bank_mask:0xf
    s_nop 1
    v_add_f32_dpp v17, v17, v17 row_ror:2 row_mask:0xf bank_mask:0xf
    s_nop 1
    v_add_f32_dpp v17, v17, v17 row_ror:1 row_mask:0xf bank_mask:0xf
    v_rcp_f32 v17, v17
    s_nop 0
    v_mul_f32 v22, v22, v17
    v_mul_f32 v23, v23, v17
    v_lshrrev_b32 v16, 2, v1
    v_and_b32 v17, 3, v0
    v_lshl_add_u32 v18, v2, 2, v16
    v_mul_u32_u24 v27, 896, v18
    v_lshl_add_u32 v27, v17, 3, v27
    s_mul_i32 s60, s63, 32
    s_add_u32 s60, s60, 131072
    v_add_u32 v27, s60, v27
    s_mul_i32 s60, s28, 53760
    s_lshl_b32 s61, s29, 6
    s_add_u32 s60, s60, s61
    s_mul_i32 s61, s63, 1920
    s_add_u32 s64, s60, s61
    v_mul_u32_u24 v31, 1920, v1
    v_lshl_add_u32 v31, v2, 4, v31
    s_mul_i32 s60, s28, 69632
    s_mul_i32 s61, s29, 2176
    s_add_u32 s60, s60, s61
    s_lshl_b32 s61, s63, 6
    s_add_u32 s60, s60, s61
    s_add_u32 s60, s60, 196608
    v_add_u32 v30, s60, v28
    v_mov_b32 v96, 0
    v_mov_b32 v97, 0
    v_mov_b32 v98, 0
    v_mov_b32 v99, 0
    s_cbranch_execz L_g_30
    global_load_dwordx4 v[4:7], v29, s[26:27] sc1
    global_load_dwordx4 v[8:11], v29, s[26:27] offset:1024 sc1
L_g_30:
    s_branch L_wl_31
L_wl_31_r:
    s_sub_u32 s38, s38, 1
    s_cbranch_scc1 L_abort
L_wl_31:
    ds_read_b32 v16, v26
    s_waitcnt lgkmcnt(0)
    v_cmp_gt_u32 vcc, 156, v16
    s_cbranch_vccnz L_wl_31_r
    ds_read_b64_tr_b16 v[64:65], v27 offset:0
    ds_read_b64_tr_b16 v[66:67], v27 offset:32
    ds_read_b64_tr_b16 v[68:69], v27 offset:64
    ds_read_b64_tr_b16 v[70:71], v27 offset:96
    ds_read_b64_tr_b16 v[72:73], v27 offset:128
    ds_read_b64_tr_b16 v[74:75], v27 offset:160
    ds_read_b64_tr_b16 v[76:77], v27 offset:192
    s_branch L_bg_32
L_bg_32_r:
    s_sub_u32 s38, s38, 1
    s_cbranch_scc1 L_abort
    s_mov_b64 exec, vcc
    global_load_dwordx4 v[4:7], v29, s[26:27] sc1
    global_load_dwordx4 v[8:11], v29, s[26:27] offset:1024 sc1
    s_mov_b64 exec, s[66:67]
L_bg_32:
    s_waitcnt vmcnt(0)
    v_xor_b32 v32, s32, v4
    v_xor_b32 v33, s33, v5
    v_xor_b32 v34, s34, v6
    v_xor_b32 v35, s35, v7
    v_xor_b32 v36, s32, v8
    v_xor_b32 v37, s33, v9
    v_xor_b32 v38, s34, v10
    v_xor_b32 v39, s35, v11
    v_or3_b32 v12, v32, v33, v34
    v_or3_b32 v12, v12, v35, v36
    v_or3_b32 v12, v12, v37, v38
    v_or_b32 v12, v12, v39
    v_and_b32 v12, v3, v12
    v_cmp_ne_u32 vcc, 0, v12
    s_cbranch_vccnz L_bg_32_r
    v_mov_b32 v16, 148692
    v_mov_b32 v17, 1
    s_and_b64 exec, s[66:67], 1
    ds_add_u32 v16, v17
    s_mov_b64 exec, s[66:67]
    v_mul_f32 v32, v22, v32
    v_mul_f32 v33, v22, v33
    v_mul_f32 v34, v22, v34
    v_mul_f32 v35, v22, v35
    v_fmac_f32 v32, v23, v36
    v_fmac_f32 v33, v23, v37
    v_fmac_f32 v34, v23, v38
    v_fmac_f32 v35, v23, v39
    v_add_f32_dpp v32, v32, v32 row_ror:8 row_mask:0xf bank_mask:0xf
    v_add_f32_dpp v33, v33, v33 row_ror:8 row_mask:0xf bank_mask:0xf
    v_add_f32_dpp v34, v34, v34 row_ror:8 row_mask:0xf bank_mask:0xf
    v_add_f32_dpp v35, v35, v35 row_ror:8 row_mask:0xf bank_mask:0xf
    v_add_f32_dpp v32, v32, v32 row_ror:4 row_mask:0xf bank_mask:0xf
    v_add_f32_dpp v33, v33, v33 row_ror:4 row_mask:0xf bank_mask:0xf
    v_add_f32_dpp v34, v34, v34 row_ror:4 row_mask:0xf bank_mask:0xf
    v_add_f32_dpp v35, v35, v35 row_ror:4 row_mask:0xf bank_mask:0xf
    v_add_f32_dpp v32, v32, v32 row_ror:2 row_mask:0xf bank_mask:0xf
    v_add_f32_dpp v33, v33, v33 row_ror:2 row_mask:0xf bank_mask:0xf
    v_add_f32_dpp v34, v34, v34 row_ror:2 row_mask:0xf bank_mask:0xf
    v_add_f32_dpp v35, v35, v35 row_ror:2 row_mask:0xf bank_mask:0xf
    v_add_f32_dpp v32, v32, v32 row_ror:1 row_mask:0xf bank_mask:0xf
    v_add_f32_dpp v33, v33, v33 row_ror:1 row_mask:0xf bank_mask:0xf
    v_add_f32_dpp v34, v34, v34 row_ror:1 row_mask:0xf bank_mask:0xf
    v_add_f32_dpp v35, v35, v35 row_ror:1 row_mask:0xf bank_mask:0xf
    v_cvt_pk_bf16_f32 v40, v32, v33
    v_cvt_pk_bf16_f32 v41, v34, v35
    s_waitcnt lgkmcnt(0)
    ds_read_b32 v17, v16
    v_cndmask_b32 v12, 0, v40, s[40:41]
    v_cndmask_b32 v13, 0, v41, s[40:41]
    s_nop 1
    v_mfma_f32_16x16x16_bf16 v[96:99], v[64:65], v[12:13], v[96:99]
    v_cndmask_b32 v14, 0, v40, s[42:43]
    v_cndmask_b32 v15, 0, v41, s[42:43]
    s_nop 1
    v_mfma_f32_16x16x16_bf16 v[96:99], v[66:67], v[14:15], v[96:99]
    v_cndmask_b32 v12, 0, v40, s[44:45]
    v_cndmask_b32 v13, 0, v41, s[44:45]
    s_nop 1
    v_mfma_f32_16x16x16_bf16 v[96:99], v[68:69], v[12:13], v[96:99]
    v_cndmask_b32 v14, 0, v40, s[46:47]
    v_cndmask_b32 v15, 0, v41, s[46:47]
    s_nop 1
    v_mfma_f32_16x16x16_bf16 v[96:99], v[70:71], v[14:15], v[96:99]
    v_cndmask_b32 v12, 0, v40, s[48:49]
    v_cndmask_b32 v13, 0, v41, s[48:49]
    s_nop 1
    v_mfma_f32_16x16x16_bf16 v[96:99], v[72:73], v[12:13], v[96:99]
    v_cndmask_b32 v14, 0, v40, s[50:51]
    v_cndmask_b32 v15, 0, v41, s[50:51]
    s_nop 1
    v_mfma_f32_16x16x16_bf16 v[96:99], v[74:75], v[14:15], v[96:99]
    v_cndmask_b32 v12, 0, v40, s[52:53]
    v_cndmask_b32 v13, 0, v41, s[52:53]
    s_nop 1
    v_mfma_f32_16x16x16_bf16 v[96:99], v[76:77], v[12:13], v[96:99]
    s_xor_b32 s32, s32, 0x155
    s_xor_b32 s33, s33, 0x155
    s_xor_b32 s34, s34, 0x155
    s_xor_b32 s35, s35, 0x155
L_bgw_33:
    s_waitcnt lgkmcnt(0)
    v_cmp_ne_u32 vcc, 4, v17
    s_cbranch_vccz L_bgw_33_ok
    s_sub_u32 s38, s38, 1
    s_cbranch_scc1 L_abort
    ds_read_b32 v17, v16
    s_branch L_bgw_33
L_bgw_33_ok:
    v_bfi_b32 v8, v3, s32, v96
    v_bfi_b32 v9, v3, s33, v97
    v_bfi_b32 v10, v3, s34, v98
    v_bfi_b32 v11, v3, s35, v99
    s_and_b32 exec_lo, s66, 0x7f007f
    s_and_b32 exec_hi, s67, 0x7f007f
    s_cbranch_execz L_gst_34_b
    s_cmp_eq_u32 s37, 1
    s_cbranch_scc0 L_gst_34
    global_store_dwordx4 v30, v[8:11], s[26:27]
L_gst_34_b:
    s_mov_b64 exec, s[66:67]
    s_xor_b32 s32, s32, 0x155
    s_xor_b32 s33, s33, 0x155
    s_xor_b32 s34, s34, 0x155
    s_xor_b32 s35, s35, 0x155
    v_mov_b32 v4, 148676
    v_mov_b32 v5, 1
    s_and_b64 exec, s[66:67], 1
    ds_add_u32 v4, v5
    s_mov_b64 exec, s[66:67]
    s_cmp_ge_u32 s29, 28
    s_cbranch_scc1 L_red
    s_mul_i32 s60, s28, 28800
    s_lshl_b32 s61, s29, 10
    s_add_u32 s60, s60, s61
    s_add_u32 s60, s60, 2097152
    v_and_b32 v4, 7, v1
    v_lshlrev_b32 v4, 7, v4
    v_lshl_add_u32 v4, v2, 4, v4
    v_add_u32 v29, s60, v4
    v_lshrrev_b32 v6, 2, v1
    v_and_b32 v7, 3, v0
    v_lshl_add_u32 v8, v2, 2, v6
    v_mul_u32_u24 v8, 448, v8
    v_and_b32 v9, 1, v7
    v_lshl_add_u32 v8, v9, 3, v8
    v_lshrrev_b32 v9, 1, v7
    v_mul_u32_u24 v9, 7168, v9
    v_add_u32 v8, v8, v9
    s_lshl_b32 s60, s63, 4
    s_add_u32 s60, s60, 0
    v_add_u32 v27, s60, v8
    s_mul_i32 s60, s28, 103936
    s_lshl_b32 s61, s29, 7
    s_add_u32 s60, s60, s61
    s_mul_i32 s61, s63, 3712
    s_add_u32 s60, s60, s61
    s_add_u32 s60, s60, 786432
    v_and_b32 v4, 7, v1
    v_mul_u32_u24 v4, 3712, v4
    v_lshrrev_b32 v5, 3, v1
    v_lshl_add_u32 v4, v5, 6, v4
    v_lshl_add_u32 v4, v2, 4, v4
    v_add_u32 v30, s60, v4
    s_lshl_b32 s60, s28, 5
    s_add_u32 s60, s60, s29
    s_lshl_b32 s60, s60, 4
    s_add_u32 s60, s60, 12288
    v_mov_b32 v4, s60
    v_cndmask_b32 v30, v30, v4, s[54:55]
    v_mov_b32 v4, 0x3f803f80
    v_cmp_eq_u32 vcc, 8, v1
    s_nop 1
    v_cndmask_b32 v80, 0, v4, vcc
    v_cmp_eq_u32 vcc, 9, v1
    s_nop 1
    v_cndmask_b32 v81, 0, v4, vcc
    v_cmp_eq_u32 vcc, 10, v1
    s_nop 1
    v_cndmask_b32 v82, 0, v4, vcc
    v_cmp_eq_u32 vcc, 11, v1
    s_nop 1
    v_cndmask_b32 v83, 0, v4, vcc
    v_cmp_eq_u32 vcc, 12, v1
    s_nop 1
    v_cndmask_b32 v84, 0, v4, vcc
    v_cmp_eq_u32 vcc, 13, v1
    s_nop 1
    v_cndmask_b32 v85, 0, v4, vcc
    v_cmp_eq_u32 vcc, 14, v1
    s_nop 1
    v_cndmask_b32 v86, 0, v4, vcc
    v_lshlrev_b32 v44, 16, v20
    v_and_b32 v45, 0xffff0000, v20
    v_lshlrev_b32 v46, 16, v21
    v_and_b32 v47, 0xffff0000, v21
    s_mov_b32 s60, 0xaaaaaaaa
    s_mov_b32 s61, 0xaaaaaaaa
    v_mov_b32 v42, 0x3f803f80
    v_mov_b32 v96, 0
    v_mov_b32 v97, 0
    v_mov_b32 v98, 0
    v_mov_b32 v99, 0
    s_branch L_wl_35
L_wl_35_r:
    s_sub_u32 s38, s38, 1
    s_cbranch_scc1 L_abort
L_wl_35:
    ds_read_b32 v16, v26
    s_waitcnt lgkmcnt(0)
    v_cmp_gt_u32 vcc, 170, v16
    s_cbranch_vccnz L_wl_35_r
    s_cbranch_execz L_g_36
    global_load_dwordx4 v[4:7], v29, s[26:27] sc1
L_g_36:
    ds_read_b64_tr_b16 v[64:65], v27 offset:0
    ds_read_b64_tr_b16 v[66:67], v27 offset:16
    ds_read_b64_tr_b16 v[68:69], v27 offset:32
    ds_read_b64_tr_b16 v[70:71], v27 offset:48
    ds_read_b64_tr_b16 v[72:73], v27 offset:64
    ds_read_b64_tr_b16 v[74:75], v27 offset:80
    ds_read_b64_tr_b16 v[76:77], v27 offset:96
    s_branch L_c1_37
L_c1_37_r:
    s_sub_u32 s38, s38, 1
    s_cbranch_scc1 L_abort
    s_mov_b64 exec, vcc
    global_load_dwordx4 v[4:7], v29, s[26:27] sc1
    s_mov_b64 exec, s[66:67]
L_c1_37:
    s_waitcnt vmcnt(0)
    v_xor_b32 v32, s32, v4
    v_xor_b32 v33, s33, v5
    v_xor_b32 v34, s34, v6
    v_xor_b32 v35, s35, v7
    v_or3_b32 v12, v32, v33, v34
    v_or_b32 v12, v12, v35
    v_and_b32 v12, v3, v12
    v_cmp_ne_u32 vcc, 0, v12
    s_cbranch_vccnz L_c1_37_r
    v_add_f32_dpp v32, v32, v32 row_ror:4 row_mask:0xf bank_mask:0xf
    v_add_f32_dpp v33, v33, v33 row_ror:4 row_mask:0xf bank_mask:0xf
    v_add_f32_dpp v34, v34, v34 row_ror:4 row_mask:0xf bank_mask:0xf
    v_add_f32_dpp v35, v35, v35 row_ror:4 row_mask:0xf bank_mask:0xf
    v_add_f32_dpp v32, v32, v32 row_ror:2 row_mask:0xf bank_mask:0xf
    v_add_f32_dpp v33, v33, v33 row_ror:2 row_mask:0xf bank_mask:0xf
    v_add_f32_dpp v34, v34, v34 row_ror:2 row_mask:0xf bank_mask:0xf
    v_add_f32_dpp v35, v35, v35 row_ror:2 row_mask:0xf bank_mask:0xf
    v_add_f32_dpp v32, v32, v32 row_ror:1 row_mask:0xf bank_mask:0xf
    v_add_f32_dpp v33, v33, v33 row_ror:1 row_mask:0xf bank_mask:0xf
    v_add_f32_dpp v34, v34, v34 row_ror:1 row_mask:0xf bank_mask:0xf
    v_add_f32_dpp v35, v35, v35 row_ror:1 row_mask:0xf bank_mask:0xf
    v_cvt_pk_bf16_f32 v4, v32, v33
    v_cvt_pk_bf16_f32 v5, v34, v35
    v_lshlrev_b32 v32, 16, v4
    v_and_b32 v33, 0xffff0000, v4
    v_lshlrev_b32 v34, 16, v5
    v_and_b32 v35, 0xffff0000, v5
    v_add_f32 v32, v32, v44
    v_add_f32 v33, v33, v45
    v_add_f32 v34, v34, v46
    v_add_f32 v35, v35, v47
    v_cvt_pk_bf16_f32 v24, v32, v33
    v_cvt_pk_bf16_f32 v25, v34, v35
    s_waitcnt lgkmcnt(0)
    v_cndmask_b32 v12, v80, v24, s[40:41]
    v_cndmask_b32 v13, v80, v25, s[40:41]
    s_nop 1
    v_mfma_f32_16x16x16_bf16 v[96:99], v[64:65], v[12:13], v[96:99]
    v_cndmask_b32 v14, v81, v24, s[42:43]
    v_cndmask_b32 v15, v81, v25, s[42:43]
    s_nop 1
    v_mfma_f32_16x16x16_bf16 v[96:99], v[66:67], v[14:15], v[96:99]
    v_cndmask_b32 v12, v82, v24, s[44:45]
    v_cndmask_b32 v13, v82, v25, s[44:45]
    s_nop 1
    v_mfma_f32_16x16x16_bf16 v[96:99], v[68:69], v[12:13], v[96:99]
    v_cndmask_b32 v14, v83, v24, s[46:47]
    v_cndmask_b32 v15, v83, v25, s[46:47]
    s_nop 1
    v_mfma_f32_16x16x16_bf16 v[96:99], v[70:71], v[14:15], v[96:99]
    v_cndmask_b32 v12, v84, v24, s[48:49]
    v_cndmask_b32 v13, v84, v25, s[48:49]
    s_nop 1
    v_mfma_f32_16x16x16_bf16 v[96:99], v[72:73], v[12:13], v[96:99]
    v_cndmask_b32 v14, v85, v24, s[50:51]
    v_cndmask_b32 v15, v85, v25, s[50:51]
    s_nop 1
    v_mfma_f32_16x16x16_bf16 v[96:99], v[74:75], v[14:15], v[96:99]
    v_cndmask_b32 v12, v86, v24, s[52:53]
    v_cndmask_b32 v13, v86, v25, s[52:53]
    s_nop 1
    v_mfma_f32_16x16x16_bf16 v[96:99], v[76:77], v[12:13], v[96:99]
    v_cndmask_b32 v6, v42, v24, s[60:61]
    v_cndmask_b32 v7, v42, v25, s[60:61]
    v_cndmask_b32 v12, 0, v24, s[54:55]
    v_cndmask_b32 v13, 0, v25, s[54:55]
    s_nop 1
    v_mfma_f32_16x16x16_bf16 v[96:99], v[6:7], v[12:13], v[96:99]
    s_mov_b32 s3, 0x7f7f7f7f
    s_cmp_eq_u32 s30, 0
    s_cmov_b32 s3, 0x7f7f7fff
    s_nop 4
    v_bfi_b32 v8, v3, s32, v96
    v_bfi_b32 v9, v3, s33, v97
    v_bfi_b32 v10, v3, s34, v98
    v_bfi_b32 v11, v3, s35, v99
    s_and_b32 exec_lo, s66, s3
    s_and_b32 exec_hi, s67, 0x7f7f7f7f
    s_cbranch_execz L_gst_38_b
    s_cmp_eq_u32 s37, 1
    s_cbranch_scc0 L_gst_38
    global_store_dwordx4 v30, v[8:11], s[26:27]
L_gst_38_b:
    s_mov_b64 exec, s[66:67]
    s_lshl_b32 s60, s63, 5
    v_lshrrev_b32 v6, 2, v1
    v_and_b32 v7, 3, v0
    v_and_b32 v8, 1, v2
    v_lshl_add_u32 v8, v8, 2, v6
    v_mul_u32_u24 v8, 896, v8
    v_lshl_add_u32 v8, v7, 3, v8
    s_add_u32 s3, s60, 16384
    v_add_u32 v27, s3, v8
    s_add_u32 s60, s64, 1638400
    v_add_u32 v30, s60, v31
    s_mov_b32 s40, 0x10001
    s_mov_b32 s41, 0x0
    s_mov_b32 s42, 0x20002
    s_mov_b32 s43, 0x0
    s_mov_b32 s44, 0x40004
    s_mov_b32 s45, 0x0
    s_mov_b32 s46, 0x80008
    s_mov_b32 s47, 0x0
    s_mov_b32 s48, 0x100010
    s_mov_b32 s49, 0x0
    s_mov_b32 s50, 0x200020
    s_mov_b32 s51, 0x0
    s_mov_b32 s52, 0x400040
    s_mov_b32 s53, 0x0
    s_mov_b32 s54, 0x800080
    s_mov_b32 s55, 0x0
    v_mov_b32 v96, 0
    v_mov_b32 v97, 0
    v_mov_b32 v98, 0
    v_mov_b32 v99, 0
    v_and_b32 v4, 1, v2
    v_lshlrev_b32 v4, 3, v4
    v_add_u32 v19, 148704, v4
    v_mov_b32 v18, 148688
    s_branch L_wl_39
L_wl_39_r:
    s_sub_u32 s38, s38, 1
    s_cbranch_scc1 L_abort
L_wl_39:
    ds_read_b32 v4, v26
    s_waitcnt lgkmcnt(0)
    v_cmp_gt_u32 vcc, 177, v4
    s_cbranch_vccnz L_wl_39_r
    ds_read_b64_tr_b16 v[64:65], v27 offset:0
    ds_read_b64_tr_b16 v[66:67], v27 offset:32
    ds_read_b64_tr_b16 v[68:69], v27 offset:64
    ds_read_b64_tr_b16 v[70:71], v27 offset:96
    ds_read_b64_tr_b16 v[72:73], v27 offset:128
    ds_read_b64_tr_b16 v[74:75], v27 offset:160
    ds_read_b64_tr_b16 v[76:77], v27 offset:192
    s_cmp_lg_u32 s30, 0
    s_cbranch_scc1 L_actwait
    s_mul_i32 s60, s28, 103936
    s_mul_i32 s61, s29, 3712
    s_add_u32 s60, s60, s61
    s_add_u32 s60, s60, 786432
    v_lshlrev_b32 v4, 7, v1
    v_lshl_add_u32 v4, v2, 4, v4
    v_add_u32 v29, s60, v4
    s_lshl_b32 s60, s28, 9
    s_add_u32 s60, s60, 12288
    v_and_b32 v4, 1, v2
    v_lshlrev_b32 v4, 4, v4
    v_add_u32 v4, v4, v1
    v_lshl_add_u32 v17, v4, 4, s60
    v_mov_b32 v44, s32
    v_mov_b32 v48, s32
    v_mov_b32 v52, s32
    v_mov_b32 v45, s33
    v_mov_b32 v49, s33
    v_mov_b32 v53, s33
    v_mov_b32 v46, s34
    v_mov_b32 v50, s34
    v_mov_b32 v54, s34
    v_mov_b32 v47, s35
    v_mov_b32 v51, s35
    v_mov_b32 v55, s35
    s_mov_b32 s56, 0xaaaaaaaa
    s_mov_b32 s57, 0xaaaaaaaa
    s_mov_b32 s58, 0xcccccccc
    s_mov_b32 s59, 0xcccccccc
    v_mov_b32 v16, 0xbdd2d3e8
    v_mov_b32 v22, 0xc0135761
    v_lshlrev_b32 v20, 3, v2
    v_lshl_add_u32 v20, v1, 1, v20
    v_add_u32 v20, 148704, v20
    v_mov_b32 v21, 1
    s_and_b32 exec_lo, s66, 0xfffffff
    s_and_b32 exec_hi, s67, 0xfffffff
    s_cbranch_execz L_g_40
    global_load_dwordx4 v[52:55], v17, s[26:27] sc1
L_g_40:
    s_mov_b64 exec, s[66:67]
    s_cbranch_execz L_g_41
    global_load_dwordx4 v[4:7], v29, s[26:27] sc1
L_g_41:
    s_cbranch_execz L_g_42
    global_load_dwordx4 v[8:11], v29, s[26:27] offset:64 sc1
L_g_42:
    s_and_b32 exec_lo, s66, 0xfff0fff
    s_and_b32 exec_hi, s67, 0xfff0fff
    s_cbranch_execz L_g_43
    global_load_dwordx4 v[44:47], v29, s[26:27] offset:2048 sc1
L_g_43:
    s_cbranch_execz L_g_44
    global_load_dwordx4 v[48:51], v29, s[26:27] offset:2112 sc1
L_g_44:
    s_mov_b64 exec, s[66:67]
    s_branch L_dg_45
L_dg_45_r:
    s_sub_u32 s38, s38, 1
    s_cbranch_scc1 L_abort
    s_and_b32 exec_lo, vcc_lo, 0xfffffff
    s_and_b32 exec_hi, vcc_hi, 0xfffffff
    global_load_dwordx4 v[52:55], v17, s[26:27] sc1
    s_mov_b64 exec, vcc
    global_load_dwordx4 v[4:7], v29, s[26:27] sc1
    global_load_dwordx4 v[8:11], v29, s[26:27] offset:64 sc1
    s_and_b32 exec_lo, vcc_lo, 0xfff0fff
    s_and_b32 exec_hi, vcc_hi, 0xfff0fff
    global_load_dwordx4 v[44:47], v29, s[26:27] offset:2048 sc1
    global_load_dwordx4 v[48:51], v29, s[26:27] offset:2112 sc1
    s_mov_b64 exec, s[66:67]
L_dg_45:
    s_waitcnt vmcnt(0)
    v_xor_b32 v60, s32, v52
    v_xor_b32 v61, s33, v53
    v_xor_b32 v62, s34, v54
    v_xor_b32 v63, s35, v55
    v_xor_b32 v32, s32, v4
    v_xor_b32 v33, s33, v5
    v_xor_b32 v34, s34, v6
    v_xor_b32 v35, s35, v7
    v_xor_b32 v36, s32, v8
    v_xor_b32 v37, s33, v9
    v_xor_b32 v38, s34, v10
    v_xor_b32 v39, s35, v11
    v_xor_b32 v40, s32, v44
    v_xor_b32 v41, s33, v45
    v_xor_b32 v42, s34, v46
    v_xor_b32 v43, s35, v47
    v_xor_b32 v56, s32, v48
    v_xor_b32 v57, s33, v49
    v_xor_b32 v58, s34, v50
    v_xor_b32 v59, s35, v51
    v_or3_b32 v12, v60, v61, v62
    v_or3_b32 v12, v12, v63, v32
    v_or3_b32 v12, v12, v33, v34
    v_or3_b32 v12, v12, v35, v36
    v_or3_b32 v12, v12, v37, v38
    v_or3_b32 v12, v12, v39, v40
    v_or3_b32 v12, v12, v41, v42
    v_or3_b32 v12, v12, v43, v56
    v_or3_b32 v12, v12, v57, v58
    v_or_b32 v12, v12, v59
    v_and_b32 v12, v3, v12
    v_cmp_ne_u32 vcc, 0, v12
    s_cbranch_vccnz L_dg_45_r
    v_add_f32_dpp v60, v60, v60 row_ror:8 row_mask:0xf bank_mask:0xf
    v_add_f32_dpp v61, v61, v61 row_ror:8 row_mask:0xf bank_mask:0xf
    v_add_f32 v32, v32, v40
    v_add_f32 v33, v33, v41
    v_add_f32_dpp v60, v60, v60 row_ror:4 row_mask:0xf bank_mask:0xf
    v_add_f32_dpp v61, v61, v61 row_ror:4 row_mask:0xf bank_mask:0xf
    v_add_f32 v34, v34, v42
    v_add_f32 v35, v35, v43
    v_add_f32_dpp v60, v60, v60 row_ror:2 row_mask:0xf bank_mask:0xf
    v_add_f32_dpp v61, v61, v61 row_ror:2 row_mask:0xf bank_mask:0xf
    v_add_f32 v36, v36, v56
    v_add_f32 v37, v37, v57
    v_add_f32_dpp v60, v60, v60 row_ror:1 row_mask:0xf bank_mask:0xf
    v_add_f32_dpp v61, v61, v61 row_ror:1 row_mask:0xf bank_mask:0xf
    v_add_f32 v38, v38, v58
    v_add_f32 v39, v39, v59
    v_mov_b32 v4, v60
    v_mov_b32 v5, v61
    s_nop 0
    v_permlane16_swap_b32 v60, v4
    v_permlane16_swap_b32 v61, v5
    v_add_f32 v60, v60, v4
    v_add_f32 v61, v61, v5
    v_mul_f32 v60, 0x3b124925, v60
    v_mul_f32 v61, 0x3b124925, v61
    v_fma_f32 v61, -v60, v60, v61
    v_cvt_pk_bf16_f32 v4, v60, v61
    v_lshlrev_b32 v60, 16, v4
    v_and_b32 v61, 0xffff0000, v4
    v_fma_f32 v32, -v60, v36, v32
    v_fma_f32 v33, -v60, v37, v33
    v_fma_f32 v34, -v60, v38, v34
    v_fma_f32 v35, -v60, v39, v35
    v_add_f32_dpp v32, v32, v32 row_ror:8 row_mask:0xf bank_mask:0xf
    v_add_f32_dpp v33, v33, v33 row_ror:8 row_mask:0xf bank_mask:0xf
    v_add_f32 v61, 0x3727c5ac, v61
    v_add_f32_dpp v34, v34, v34 row_ror:8 row_mask:0xf bank_mask:0xf
    v_add_f32_dpp v35, v35, v35 row_ror:8 row_mask:0xf bank_mask:0xf
    v_cvt_pk_bf16_f32 v4, v61, v61
    v_add_f32_dpp v32, v32, v32 row_ror:4 row_mask:0xf bank_mask:0xf
    v_add_f32_dpp v33, v33, v33 row_ror:4 row_mask:0xf bank_mask:0xf
    v_lshlrev_b32 v61, 16, v4
    v_add_f32_dpp v34, v34, v34 row_ror:4 row_mask:0xf bank_mask:0xf
    v_add_f32_dpp v35, v35, v35 row_ror:4 row_mask:0xf bank_mask:0xf
    v_sqrt_f32 v61, v61
    v_add_f32_dpp v32, v32, v32 row_ror:2 row_mask:0xf bank_mask:0xf
    v_add_f32_dpp v33, v33, v33 row_ror:2 row_mask:0xf bank_mask:0xf
    v_cvt_pk_bf16_f32 v4, v61, v61
    v_add_f32_dpp v34, v34, v34 row_ror:2 row_mask:0xf bank_mask:0xf
    v_add_f32_dpp v35, v35, v35 row_ror:2 row_mask:0xf bank_mask:0xf
    v_lshlrev_b32 v61, 16, v4
    v_add_f32_dpp v32, v32, v32 row_ror:1 row_mask:0xf bank_mask:0xf
    v_add_f32_dpp v33, v33, v33 row_ror:1 row_mask:0xf bank_mask:0xf
    v_rcp_f32 v61, v61
    v_add_f32_dpp v34, v34, v34 row_ror:1 row_mask:0xf bank_mask:0xf
    v_add_f32_dpp v35, v35, v35 row_ror:1 row_mask:0xf bank_mask:0xf
    v_cndmask_b32 v32, v32, v33, s[56:57]
    v_cndmask_b32 v34, v34, v35, s[56:57]
    v_cndmask_b32 v32, v32, v34, s[58:59]
    v_mul_f32 v32, v32, v61
    v_cvt_pk_bf16_f32 v4, v32, v32
    v_lshlrev_b32 v32, 16, v4
    v_mov_b32 v36, v32
    s_nop 1
    v_permlane32_swap_b32 v32, v36
    v_mul_f32 v40, v32, v32
    v_fma_f32 v40, v40, v16, v22
    v_mul_f32 v40, v40, v32
    v_exp_f32 v40, v40
    s_nop 0
    v_add_f32 v40, 1.0, v40
    v_rcp_f32 v40, v40
    s_nop 0
    v_mul_f32 v40, v40, v32
    v_cvt_pk_bf16_f32 v4, v40, v40
    v_lshlrev_b32 v40, 16, v4
    v_mul_f32 v40, v40, v36
    v_cvt_pk_bf16_f32 v40, v40, v40
    s_and_b32 exec_lo, s66, 0xf000f
    s_and_b32 exec_hi, s67, 0x0
    ds_write_b16 v20, v40
    s_and_b64 exec, s[66:67], 1
    ds_write_b32 v18, v21
    s_mov_b64 exec, s[66:67]
L_actwait:
    s_branch L_aw_46
L_aw_46_r:
    s_sub_u32 s38, s38, 1
    s_cbranch_scc1 L_abort
L_aw_46:
    ds_read_b32 v4, v18
    ds_read_b64 v[16:17], v19
    s_waitcnt lgkmcnt(0)
    v_cmp_ne_u32 vcc, 1, v4
    s_cbranch_vccnz L_aw_46_r
    v_cndmask_b32 v12, 0, v16, s[40:41]
    v_cndmask_b32 v13, 0, v17, s[40:41]
    s_nop 1
    v_mfma_f32_16x16x16_bf16 v[96:99], v[64:65], v[12:13], v[96:99]
    v_cndmask_b32 v14, 0, v16, s[42:43]
    v_cndmask_b32 v15, 0, v17, s[42:43]
    s_nop 1
    v_mfma_f32_16x16x16_bf16 v[96:99], v[66:67], v[14:15], v[96:99]
    v_cndmask_b32 v12, 0, v16, s[44:45]
    v_cndmask_b32 v13, 0, v17, s[44:45]
    s_nop 1
    v_mfma_f32_16x16x16_bf16 v[96:99], v[68:69], v[12:13], v[96:99]
    v_cndmask_b32 v14, 0, v16, s[46:47]
    v_cndmask_b32 v15, 0, v17, s[46:47]
    s_nop 1
    v_mfma_f32_16x16x16_bf16 v[96:99], v[70:71], v[14:15], v[96:99]
    v_cndmask_b32 v12, 0, v16, s[48:49]
    v_cndmask_b32 v13, 0, v17, s[48:49]
    s_nop 1
    v_mfma_f32_16x16x16_bf16 v[96:99], v[72:73], v[12:13], v[96:99]
    v_cndmask_b32 v14, 0, v16, s[50:51]
    v_cndmask_b32 v15, 0, v17, s[50:51]
    s_nop 1
    v_mfma_f32_16x16x16_bf16 v[96:99], v[74:75], v[14:15], v[96:99]
    v_cndmask_b32 v12, 0, v16, s[52:53]
    v_cndmask_b32 v13, 0, v17, s[52:53]
    s_nop 1
    v_mfma_f32_16x16x16_bf16 v[96:99], v[76:77], v[12:13], v[96:99]
    s_nop 7
    v_bfi_b32 v8, v3, s32, v96
    v_bfi_b32 v9, v3, s33, v97
    v_bfi_b32 v10, v3, s34, v98
    v_bfi_b32 v11, v3, s35, v99
    s_and_b32 exec_lo, s66, 0x7f007f
    s_and_b32 exec_hi, s67, 0x7f007f
    s_cbranch_execz L_gst_47_b
    s_cmp_eq_u32 s37, 1
    s_cbranch_scc0 L_gst_47
    global_store_dwordx4 v30, v[8:11], s[26:27]
L_gst_47_b:
    s_mov_b64 exec, s[66:67]
    s_cmp_lg_u32 s30, 0
    s_cbranch_scc1 L_end
    s_and_b32 s60, s29, 7
    s_cmp_lg_u32 s60, s28
    s_cbranch_scc1 L_fin
    s_lshl_b32 s60, s29, 10
    s_add_u32 s60, s60, 45056
    v_and_b32 v4, 7, v1
    v_lshlrev_b32 v4, 7, v4
    v_lshl_add_u32 v4, v2, 4, v4
    v_add_u32 v29, s60, v4
    s_lshl_b32 s60, s29, 5
    v_lshl_add_u32 v30, v2, 3, s60
    v_lshlrev_b32 v36, 16, v24
    v_and_b32 v37, 0xffff0000, v24
    v_lshlrev_b32 v38, 16, v25
    v_and_b32 v39, 0xffff0000, v25
    s_cbranch_execz L_g_48
    s_sleep 22
L_g_48:
    s_cbranch_execz L_g_49
    global_load_dwordx4 v[4:7], v29, s[26:27] sc1
L_g_49:
    s_branch L_e1_50
L_e1_50_r:
    s_sub_u32 s38, s38, 1
    s_cbranch_scc1 L_abort
    s_mov_b64 exec, vcc
    global_load_dwordx4 v[4:7], v29, s[26:27] sc1
    s_mov_b64 exec, s[66:67]
L_e1_50:
    s_waitcnt vmcnt(0)
    v_xor_b32 v32, s32, v4
    v_xor_b32 v33, s33, v5
    v_xor_b32 v34, s34, v6
    v_xor_b32 v35, s35, v7
    v_or3_b32 v12, v32, v33, v34
    v_or_b32 v12, v12, v35
    v_and_b32 v12, v3, v12
    v_cmp_ne_u32 vcc, 0, v12
    s_cbranch_vccnz L_e1_50_r
    v_add_f32_dpp v32, v32, v32 row_ror:4 row_mask:0xf bank_mask:0xf
    v_add_f32_dpp v33, v33, v33 row_ror:4 row_mask:0xf bank_mask:0xf
    v_add_f32_dpp v34, v34, v34 row_ror:4 row_mask:0xf bank_mask:0xf
    v_add_f32_dpp v35, v35, v35 row_ror:4 row_mask:0xf bank_mask:0xf
    v_add_f32_dpp v32, v32, v32 row_ror:2 row_mask:0xf bank_mask:0xf
    v_add_f32_dpp v33, v33, v33 row_ror:2 row_mask:0xf bank_mask:0xf
    v_add_f32_dpp v34, v34, v34 row_ror:2 row_mask:0xf bank_mask:0xf
    v_add_f32_dpp v35, v35, v35 row_ror:2 row_mask:0xf bank_mask:0xf
    v_add_f32_dpp v32, v32, v32 row_ror:1 row_mask:0xf bank_mask:0xf
    v_add_f32_dpp v33, v33, v33 row_ror:1 row_mask:0xf bank_mask:0xf
    v_add_f32_dpp v34, v34, v34 row_ror:1 row_mask:0xf bank_mask:0xf
    v_add_f32_dpp v35, v35, v35 row_ror:1 row_mask:0xf bank_mask:0xf
    v_cvt_pk_bf16_f32 v4, v32, v33
    v_cvt_pk_bf16_f32 v5, v34, v35
    v_lshlrev_b32 v32, 16, v4
    v_and_b32 v33, 0xffff0000, v4
    v_lshlrev_b32 v34, 16, v5
    v_and_b32 v35, 0xffff0000, v5
    v_add_f32 v32, v32, v36
    v_add_f32 v33, v33, v37
    v_add_f32 v34, v34, v38
    v_add_f32 v35, v35, v39
    v_cvt_pk_bf16_f32 v4, v32, v33
    v_cvt_pk_bf16_f32 v5, v34, v35
    s_and_b32 exec_lo, s66, 0x10001
    s_and_b32 exec_hi, s67, 0x10001
    s_cbranch_execz L_g_51
    global_store_dwordx2 v30, v[4:5], s[22:23]
L_g_51:
    s_mov_b64 exec, s[66:67]
L_fin:
    s_cbranch_execz L_warm2
L_abort:
L_end:
    s_endpgm
L_red:
    s_sub_u32 s63, s29, 28
    s_mul_i32 s63, s63, 7
    s_add_u32 s63, s63, s30
    v_lshlrev_b32 v28, 6, v1
    v_lshl_add_u32 v28, v2, 4, v28
    s_mul_i32 s60, s28, 53760
    s_mul_i32 s61, s63, 1920
    s_add_u32 s64, s60, s61
    s_mul_i32 s60, s28, 69632
    s_lshl_b32 s61, s63, 6
    s_add_u32 s60, s60, s61
    s_add_u32 s60, s60, 196608
    v_mul_u32_u24 v29, 2176, v1
    v_lshl_add_u32 v29, v2, 4, v29
    v_add_u32 v29, s60, v29
    v_add_u32 v27, 34816, v29
    s_lshl_b32 s60, s63, 10
    s_lshl_b32 s61, s28, 7
    s_add_u32 s65, s60, s61
    v_lshrrev_b32 v5, 3, v1
    v_lshlrev_b32 v5, 6, v5
    v_lshl_add_u32 v5, v2, 4, v5
    v_and_b32 v4, 7, v1
    v_mul_u32_u24 v4, 28800, v4
    v_add_u32 v4, v4, v5
    s_add_u32 s60, s65, 2097152
    v_add_u32 v30, s60, v4
    s_add_u32 s60, s65, 45056
    v_add_u32 v31, s60, v5
    v_mov_b32 v16, 148676
    s_branch L_wf_52
L_wf_52_r:
    s_sub_u32 s38, s38, 1
    s_cbranch_scc1 L_abort
L_wf_52:
    ds_read_b32 v17, v16
    s_waitcnt lgkmcnt(0)
    v_cmp_ne_u32 vcc, 4, v17
    s_cbranch_vccnz L_wf_52_r
    s_xor_b32 s32, s32, 0x155
    s_xor_b32 s33, s33, 0x155
    s_xor_b32 s34, s34, 0x155
    s_xor_b32 s35, s35, 0x155
    s_cbranch_execz L_g_53
    global_load_dwordx4 v[4:7], v29, s[26:27] sc1
L_g_53:
    s_cbranch_execz L_g_54
    global_load_dwordx4 v[8:11], v27, s[26:27] sc1
L_g_54:
    s_branch L_c0_55
L_c0_55_r:
    s_sub_u32 s38, s38, 1
    s_cbranch_scc1 L_abort
    s_mov_b64 exec, vcc
    global_load_dwordx4 v[4:7], v29, s[26:27] sc1
    global_load_dwordx4 v[8:11], v27, s[26:27] sc1
    s_mov_b64 exec, s[66:67]
L_c0_55:
    s_waitcnt vmcnt(0)
    v_xor_b32 v32, s32, v4
    v_xor_b32 v33, s33, v5
    v_xor_b32 v34, s34, v6
    v_xor_b32 v35, s35, v7
    v_xor_b32 v36, s32, v8
    v_xor_b32 v37, s33, v9
    v_xor_b32 v38, s34, v10
    v_xor_b32 v39, s35, v11
    v_or3_b32 v12, v32, v33, v34
    v_or3_b32 v12, v12, v35, v36
    v_or3_b32 v12, v12, v37, v38
    v_or_b32 v12, v12, v39
    v_and_b32 v12, v3, v12
    v_cmp_ne_u32 vcc, 0, v12
    s_cbranch_vccnz L_c0_55_r
    s_xor_b32 s32, s32, 0x155
    s_xor_b32 s33, s33, 0x155
    s_xor_b32 s34, s34, 0x155
    s_xor_b32 s35, s35, 0x155
    v_add_f32 v32, v32, v36
    v_add_f32 v33, v33, v37
    v_add_f32 v34, v34, v38
    v_add_f32 v35, v35, v39
    v_add_f32_dpp v32, v32, v32 row_ror:8 row_mask:0xf bank_mask:0xf
    v_add_f32_dpp v33, v33, v33 row_ror:8 row_mask:0xf bank_mask:0xf
    v_add_f32_dpp v34, v34, v34 row_ror:8 row_mask:0xf bank_mask:0xf
    v_add_f32_dpp v35, v35, v35 row_ror:8 row_mask:0xf bank_mask:0xf
    v_add_f32_dpp v32, v32, v32 row_ror:4 row_mask:0xf bank_mask:0xf
    v_add_f32_dpp v33, v33, v33 row_ror:4 row_mask:0xf bank_mask:0xf
    v_add_f32_dpp v34, v34, v34 row_ror:4 row_mask:0xf bank_mask:0xf
    v_add_f32_dpp v35, v35, v35 row_ror:4 row_mask:0xf bank_mask:0xf
    v_add_f32_dpp v32, v32, v32 row_ror:2 row_mask:0xf bank_mask:0xf
    v_add_f32_dpp v33, v33, v33 row_ror:2 row_mask:0xf bank_mask:0xf
    v_add_f32_dpp v34, v34, v34 row_ror:2 row_mask:0xf bank_mask:0xf
    v_add_f32_dpp v35, v35, v35 row_ror:2 row_mask:0xf bank_mask:0xf
    v_add_f32_dpp v32, v32, v32 row_ror:1 row_mask:0xf bank_mask:0xf
    v_add_f32_dpp v33, v33, v33 row_ror:1 row_mask:0xf bank_mask:0xf
    v_add_f32_dpp v34, v34, v34 row_ror:1 row_mask:0xf bank_mask:0xf
    v_add_f32_dpp v35, v35, v35 row_ror:1 row_mask:0xf bank_mask:0xf
    v_bfi_b32 v8, v3, s32, v32
    v_bfi_b32 v9, v3, s33, v33
    v_bfi_b32 v10, v3, s34, v34
    v_bfi_b32 v11, v3, s35, v35
    s_cbranch_execz L_g_56
    global_store_dwordx4 v30, v[8:11], s[26:27] sc1
L_g_56:
    s_add_u32 s60, s64, 1638400
    v_add_u32 v29, s60, v28
    v_mov_b32 v8, s32
    v_mov_b32 v9, s33
    v_mov_b32 v10, s34
    v_mov_b32 v11, s35
    s_cbranch_execz L_g_57
    global_load_dwordx4 v[4:7], v29, s[26:27] sc1
L_g_57:
    s_and_b32 exec_lo, s66, 0xfff0fff
    s_and_b32 exec_hi, s67, 0xfff0fff
    s_cbranch_execz L_g_58
    global_load_dwordx4 v[8:11], v29, s[26:27] offset:1024 sc1
L_g_58:
    s_mov_b64 exec, s[66:67]
    s_branch L_e0_59
L_e0_59_r:
    s_sub_u32 s38, s38, 1
    s_cbranch_scc1 L_abort
    s_mov_b64 exec, vcc
    global_load_dwordx4 v[4:7], v29, s[26:27] sc1
    s_and_b32 exec_lo, vcc_lo, 0xfff0fff
    s_and_b32 exec_hi, vcc_hi, 0xfff0fff
    global_load_dwordx4 v[8:11], v29, s[26:27] offset:1024 sc1
    s_mov_b64 exec, s[66:67]
L_e0_59:
    s_waitcnt vmcnt(0)
    v_xor_b32 v32, s32, v4
    v_xor_b32 v33, s33, v5
    v_xor_b32 v34, s34, v6
    v_xor_b32 v35, s35, v7
    v_xor_b32 v36, s32, v8
    v_xor_b32 v37, s33, v9
    v_xor_b32 v38, s34, v10
    v_xor_b32 v39, s35, v11
    v_or3_b32 v12, v32, v33, v34
    v_or3_b32 v12, v12, v35, v36
    v_or3_b32 v12, v12, v37, v38
    v_or_b32 v12, v12, v39
    v_and_b32 v12, v3, v12
    v_cmp_ne_u32 vcc, 0, v12
    s_cbranch_vccnz L_e0_59_r
    v_add_f32 v32, v32, v36
    v_add_f32 v33, v33, v37
    v_add_f32 v34, v34, v38
    v_add_f32 v35, v35, v39
    v_add_f32_dpp v32, v32, v32 row_ror:8 row_mask:0xf bank_mask:0xf
    v_add_f32_dpp v33, v33, v33 row_ror:8 row_mask:0xf bank_mask:0xf
    v_add_f32_dpp v34, v34, v34 row_ror:8 row_mask:0xf bank_mask:0xf
    v_add_f32_dpp v35, v35, v35 row_ror:8 row_mask:0xf bank_mask:0xf
    v_add_f32_dpp v32, v32, v32 row_ror:4 row_mask:0xf bank_mask:0xf
    v_add_f32_dpp v33, v33, v33 row_ror:4 row_mask:0xf bank_mask:0xf
    v_add_f32_dpp v34, v34, v34 row_ror:4 row_mask:0xf bank_mask:0xf
    v_add_f32_dpp v35, v35, v35 row_ror:4 row_mask:0xf bank_mask:0xf
    v_add_f32_dpp v32, v32, v32 row_ror:2 row_mask:0xf bank_mask:0xf
    v_add_f32_dpp v33, v33, v33 row_ror:2 row_mask:0xf bank_mask:0xf
    v_add_f32_dpp v34, v34, v34 row_ror:2 row_mask:0xf bank_mask:0xf
    v_add_f32_dpp v35, v35, v35 row_ror:2 row_mask:0xf bank_mask:0xf
    v_add_f32_dpp v32, v32, v32 row_ror:1 row_mask:0xf bank_mask:0xf
    v_add_f32_dpp v33, v33, v33 row_ror:1 row_mask:0xf bank_mask:0xf
    v_add_f32_dpp v34, v34, v34 row_ror:1 row_mask:0xf bank_mask:0xf
    v_add_f32_dpp v35, v35, v35 row_ror:1 row_mask:0xf bank_mask:0xf
    v_bfi_b32 v8, v3, s32, v32
    v_bfi_b32 v9, v3, s33, v33
    v_bfi_b32 v10, v3, s34, v34
    v_bfi_b32 v11, v3, s35, v35
    s_and_b32 exec_lo, s66, 0x1010101
    s_and_b32 exec_hi, s67, 0x1010101
    s_cbranch_execz L_g_60
    global_store_dwordx4 v31, v[8:11], s[26:27] sc1
L_g_60:
    s_mov_b64 exec, s[66:67]
    s_cmp_lg_u32 s2, 224
    s_cbranch_scc1 L_ep_61
    s_cmp_lg_u32 s30, 0
    s_cbranch_scc1 L_ep_61
    v_mov_b32 v4, 0
    v_mov_b32 v5, s31
    s_and_b64 exec, s[66:67], 1
    s_cbranch_execz L_g_62
    global_store_dword v4, v5, s[26:27] sc1
L_g_62:
    s_mov_b64 exec, s[66:67]
L_ep_61:
    s_endpgm
L_warm:
    v_mov_b32 v1, 0
    v_mov_b32 v2, 0
    v_mov_b32 v3, 0
    v_mov_b32 v4, 0
    v_mov_b32 v5, 0
    v_mov_b32 v6, 0
    v_mov_b32 v7, 0
    v_mov_b32 v8, 0
    v_mov_b32 v9, 0
    v_mov_b32 v10, 0
    v_mov_b32 v11, 0
    v_mov_b32 v12, 0
    v_mov_b32 v13, 0
    v_mov_b32 v14, 0
    v_mov_b32 v15, 0
    v_mov_b32 v16, 0
    v_mov_b32 v17, 0
    v_mov_b32 v18, 0
    v_mov_b32 v19, 0
    v_mov_b32 v20, 0
    v_mov_b32 v21, 0
    v_mov_b32 v22, 0
    v_mov_b32 v23, 0
    v_mov_b32 v24, 0
    v_mov_b32 v25, 0
    v_mov_b32 v26, 0
    v_mov_b32 v27, 0
    v_mov_b32 v28, 0
    v_mov_b32 v29, 0
    v_mov_b32 v30, 0
    v_mov_b32 v31, 0
    v_mov_b32 v96, 0
    v_mov_b32 v97, 0
    v_mov_b32 v98, 0
    v_mov_b32 v99, 0
    v_mov_b32 v100, 0
    v_mov_b32 v101, 0
    v_mov_b32 v102, 0
    v_mov_b32 v103, 0
    v_mov_b32 v104, 0
    s_waitcnt lgkmcnt(0)
    s_add_u32 s26, s26, 0xf800000
    s_addc_u32 s27, s27, 0
    s_barrier
    s_mov_b32 s30, 0
    s_mov_b32 s29, s28
    s_mov_b32 s39, 1000
    s_mov_b32 s68, 0
    s_mov_b32 s69, 0
    s_mov_b32 s31, 0
    s_mov_b32 s32, 0
    s_mov_b32 s33, 0
    s_mov_b32 s34, 0
    s_mov_b32 s35, 0
    s_mov_b64 s[66:67], 0
    s_mov_b64 exec, 0
    s_branch L_afterA
L_warm2:
    s_mov_b32 s29, 28
    s_branch L_red
L_gst_19:
    global_store_dwordx4 v4, v[8:11], s[26:27] sc1
    s_branch L_gst_19_b
L_gst_26:
    global_store_dwordx4 v18, v[8:11], s[26:27] sc1
    s_branch L_gst_26_b
L_gst_34:
    global_store_dwordx4 v30, v[8:11], s[26:27] sc1
    s_branch L_gst_34_b
L_gst_38:
    global_store_dwordx4 v30, v[8:11], s[26:27] sc1
    s_branch L_gst_38_b
L_gst_47:
    global_store_dwordx4 v30, v[8:11], s[26:27] sc1
    s_branch L_gst_47_b
KEND:

.section .rodata,"a"
.p2align 6
.amdhsa_kernel sequential_preLN__sliding_block_cached__glu_gated_geglu__decode_kernel
  .amdhsa_next_free_vgpr 112
  .amdhsa_next_free_sgpr 102
  .amdhsa_accum_offset 112
  .amdhsa_group_segment_fixed_size 0
  .amdhsa_kernarg_size 96
  .amdhsa_user_sgpr_count 2
  .amdhsa_user_sgpr_kernarg_segment_ptr 1
  .amdhsa_system_sgpr_workgroup_id_x 1
  .amdhsa_float_denorm_mode_32 3
.end_amdhsa_kernel
```
